```python
import torch

def _softmax(x, axis=-1):
    return torch.softmax(x, dim=axis)
def _gelu(x):
    return torch.nn.functional.gelu(x, approximate="tanh")
def _silu(x):
    return torch.nn.functional.silu(x)
def _sigmoid(x):
    return torch.sigmoid(x)
def _layernorm(x, axis=-1, eps=1e-5):
    m = x.mean(dim=axis, keepdim=True)
    v = x.var(dim=axis, keepdim=True, unbiased=False)
    return (x - m) / torch.sqrt(v + eps)
def _scatter_add(tgt, idx, src, axis=0):
    return tgt.clone().index_add_(axis, idx, src)
def _segment_sum(src, seg, n):
    out = torch.zeros((n,) + src.shape[1:], dtype=src.dtype)
    return out.index_add_(0, seg, src)
def _pad(x, pw):
    flat = tuple(v for pair in reversed(pw) for v in pair)
    return torch.nn.functional.pad(x, flat)

kernel_name = 'parallel_sum__gqa_block_cached__moe_arch_mod__decode'

def setup_inputs():

    _w = (lambda a: (lambda t: t.to(torch.bfloat16) if t.is_floating_point() else t)(torch.as_tensor(a)))
    def _A_setup():
        B, Sq, D = 1, 1, 512
        Hq, Hkv, Sk, Dh = 32, 8, 65536, 128
        assert Hq % Hkv == 0, (Hq, Hkv)
        return {
            "x": _w((lambda *s: torch.randn(*s, dtype=torch.bfloat16) * 0.05)(B, Sq, D)),
            "k_cache": _w((lambda *s: torch.randn(*s, dtype=torch.bfloat16) * 3.2)(B, Hkv, Sk, Dh)),
            "v_cache": _w((lambda *s: torch.randn(*s, dtype=torch.bfloat16) * 1.6)(B, Hkv, Sk, Dh)),
            "wq": _w((lambda *s: torch.randn(*s, dtype=torch.bfloat16) * 3.2)(D, Hq * Dh) * (D ** -0.5)),
            "wo": _w((lambda *s: torch.randn(*s, dtype=torch.bfloat16) * 1.6)(Hq * Dh, D) * ((Hq * Dh) ** -0.5)),
        }
    _A_in = _A_setup()

    def _B_setup():
        B, S, D, F, C = 1, 1, 512, 1792, 1
        return {
            "x": _w((lambda *s: torch.randn(*s, dtype=torch.bfloat16) * 0.05)(B, S, D)),
            "w_r": _w((lambda *s: torch.randn(*s, dtype=torch.bfloat16) * 0.1)(D)),
            "w_gate": _w((lambda *s: torch.randn(*s, dtype=torch.bfloat16) * 0.1)(D, F)),
            "w_up": _w((lambda *s: torch.randn(*s, dtype=torch.bfloat16) * 0.1)(D, F)),
            "w_down": _w((lambda *s: torch.randn(*s, dtype=torch.bfloat16) * 0.1)(F, D)),
        }
    _B_in = _B_setup()

    return {
        "A_x": _A_in["x"],
        "A_k_cache": _A_in["k_cache"],
        "A_v_cache": _A_in["v_cache"],
        "A_wq": _A_in["wq"],
        "A_wo": _A_in["wo"],
        "B_x": _B_in["x"],
        "B_w_r": _B_in["w_r"],
        "B_w_gate": _B_in["w_gate"],
        "B_w_up": _B_in["w_up"],
        "B_w_down": _B_in["w_down"],
    }

def reference(A_x, A_k_cache, A_v_cache, A_wq, A_wo, B_x, B_w_r, B_w_gate, B_w_up, B_w_down):
    def _A_ref(x, k_cache, v_cache, wq, wo):
        B, Sq, D = x.shape
        Hq, Dh = 32, 128
        Hkv = k_cache.shape[1]
        rep = Hq // Hkv
        q = (lambda x, *d: x.permute(*d))((x @ wq).reshape(B, Sq, Hq, Dh), 0, 2, 1, 3)
        k = (lambda x, n, axis: torch.repeat_interleave(x, n, dim=axis))(k_cache, rep, axis=1)
        v = (lambda x, n, axis: torch.repeat_interleave(x, n, dim=axis))(v_cache, rep, axis=1)
        scores = torch.einsum("bhqd,bhkd->bhqk", q, k) * (Dh ** -0.5)
        p = _softmax(scores, axis=-1)
        o = torch.einsum("bhqk,bhkd->bhqd", p, v)
        return (lambda x, *d: x.permute(*d))(o, 0, 2, 1, 3).reshape(B, Sq, Hq * Dh) @ wo

    def _B_ref(x, w_r, w_gate, w_up, w_down):
        B, S, D = x.shape
        C = 1
        r = x @ w_r
        idx = torch.argsort(-r, axis=-1)[:, :C]
        idx_e = (lambda x, n, axis: torch.repeat_interleave(x, n, dim=axis))(idx.reshape(B, C, 1), D, axis=2)
        x_sel = (lambda x, i, axis: torch.take_along_dim(x, i, dim=axis))(x, idx_e, axis=1)
        g = _silu(x_sel @ w_gate)
        u = x_sel @ w_up
        y = (g * u) @ w_down
        r_sel = _sigmoid((lambda x, i, axis: torch.take_along_dim(x, i, dim=axis))(r, idx, axis=1))
        y = y * r_sel.reshape(B, C, 1)
        b_off = (torch.arange(B) * S).reshape(B, 1)
        flat_idx = (idx + b_off).reshape(B * C)
        zero = (x * 0.0).reshape(B * S, D)
        upd = _scatter_add(zero, flat_idx, y.reshape(B * C, D), axis=0)
        return x + upd.reshape(B, S, D)

    x = A_x
    xn = _layernorm(x, axis=-1)
    return x + _A_ref(xn, A_k_cache, A_v_cache, A_wq, A_wo) + _B_ref(xn, B_w_r, B_w_gate, B_w_up, B_w_down)
```

```asm
; @launch grid=(256,1,1) block=(576,1,1) lds=65536
.amdgcn_target "amdgcn-amd-amdhsa--gfx950"
.text
.globl parallel_sum__gqa_block_cached__moe_arch_mod__decode_kernel
.p2align 8
.type parallel_sum__gqa_block_cached__moe_arch_mod__decode_kernel,@function
parallel_sum__gqa_block_cached__moe_arch_mod__decode_kernel:
  s_cmp_ge_u32 s2, 256
  s_cbranch_scc1 L_end
  s_load_dwordx16 s[16:31], s[0:1], 0
  s_load_dwordx8 s[32:39], s[0:1], 64
  s_load_dwordx2 s[40:41], s[0:1], 96
  v_lshrrev_b32 v1, 6, v0
  v_and_b32 v0, 63, v0
  v_readfirstlane_b32 s3, v1
  s_and_b32 s4, s2, 7
  s_lshr_b32 s5, s2, 3
  s_and_b32 s5, s5, 7
  s_and_b32 s2, s2, 0xc0
  s_lshl_b32 s4, s4, 3
  s_or_b32 s2, s2, s4
  s_or_b32 s2, s2, s5
  s_and_b32 s4, s2, 7
  s_lshr_b32 s5, s2, 3
  s_mov_b32 s43, 0x3fb8aa3b
  s_mov_b32 s44, 0x05040100
  s_mov_b32 s45, 0x07060302
  s_mov_b32 s46, 0x3db504f3
  s_mov_b32 s47, 0x3db504f3
  s_cmp_eq_u32 s3, 0
  s_cbranch_scc1 L_service
  s_sub_u32 s3, s3, 1
  v_and_b32 v1, 7, v0
  v_lshlrev_b32 v1, 8, v1
  v_bfe_u32 v8, v0, 3, 1
  v_lshl_add_u32 v1, v8, 6, v1
  v_lshrrev_b32 v8, 4, v0
  v_lshl_add_u32 v1, v8, 4, v1
  v_and_b32 v2, 15, v0
  v_lshlrev_b32 v2, 4, v2
  v_bfe_u32 v8, v0, 4, 1
  v_lshl_add_u32 v2, v8, 10, v2
  v_lshrrev_b32 v8, 5, v0
  v_lshl_add_u32 v2, v8, 12, v2
  s_and_b32 s6, s5, 31
  s_lshl_b32 s6, s6, 3
  s_add_u32 s6, s6, s3
  s_lshl_b32 s6, s6, 0
  s_lshr_b32 s9, s5, 5
  s_add_u32 s6, s6, s9
  s_add_u32 s64, s6, 256
  s_add_u32 s61, s9, 1856
  s_lshl_b32 s13, s4, 24
  s_mul_i32 s62, s4, 2097152
  s_lshl_b32 s6, s6, 13
  s_add_u32 s6, s6, s62
  s_and_b32 s6, s6, 0xffffff
  s_add_u32 s6, s6, s13
  s_add_u32 s7, s6, 4096
  s_lshl_b32 s15, s64, 13
  s_add_u32 s15, s15, s62
  s_and_b32 s15, s15, 0xffffff
  s_add_u32 s15, s15, s13
  s_mul_i32 s60, s5, 3
  s_add_u32 s60, s60, s3
  s_mov_b32 s67, s60
  s_mov_b32 s60, 512
  s_cmp_lt_u32 s3, 3
  s_cselect_b32 s65, 1, 0
  s_cmp_lt_u32 s3, 3
  s_cselect_b32 s66, 1, 0
  s_lshl_b32 s9, s9, 3
  s_add_u32 s9, s9, s4
  s_mul_i32 s12, s9, 256
  s_add_u32 s12, s12, 0x8000
  v_mov_b32 v7, 0
  s_waitcnt lgkmcnt(0)
  s_load_dword s42, s[40:41], 0
  s_mov_b32 s48, s18
  s_mov_b32 s49, s19
  s_mov_b32 s50, 0x8000000
  s_mov_b32 s51, 0x20000
  s_mov_b32 s52, s20
  s_mov_b32 s53, s21
  s_mov_b32 s54, 0x8000000
  s_mov_b32 s55, 0x20000
  s_mov_b32 s56, s40
  s_mov_b32 s57, s41
  s_mov_b32 s58, 0x400000
  s_mov_b32 s59, 0x20000
  s_barrier
  buffer_load_dwordx4 v[72:75], v1, s[48:51], s6 offen offset:0 nt
  buffer_load_dwordx4 v[76:79], v1, s[48:51], s6 offen offset:128 nt
  buffer_load_dwordx4 v[80:83], v1, s[48:51], s6 offen offset:2048 nt
  buffer_load_dwordx4 v[84:87], v1, s[48:51], s6 offen offset:2176 nt
  buffer_load_dwordx4 v[88:91], v1, s[48:51], s7 offen offset:0 nt
  buffer_load_dwordx4 v[92:95], v1, s[48:51], s7 offen offset:128 nt
  buffer_load_dwordx4 v[96:99], v1, s[48:51], s7 offen offset:2048 nt
  buffer_load_dwordx4 v[100:103], v1, s[48:51], s7 offen offset:2176 nt
  buffer_load_dwordx4 v[136:139], v2, s[52:55], s6 offen offset:0 nt
  buffer_load_dwordx4 v[140:143], v2, s[52:55], s6 offen offset:256 nt
  buffer_load_dwordx4 v[144:147], v2, s[52:55], s6 offen offset:512 nt
  buffer_load_dwordx4 v[148:151], v2, s[52:55], s6 offen offset:768 nt
  buffer_load_dwordx4 v[152:155], v2, s[52:55], s6 offen offset:2048 nt
  buffer_load_dwordx4 v[156:159], v2, s[52:55], s6 offen offset:2304 nt
  buffer_load_dwordx4 v[160:163], v2, s[52:55], s6 offen offset:2560 nt
  buffer_load_dwordx4 v[164:167], v2, s[52:55], s6 offen offset:2816 nt
  v_mov_b32 v40, 0
  v_mov_b32 v41, 0
  v_mov_b32 v42, 0
  v_mov_b32 v43, 0
  v_mov_b32 v44, 0
  v_mov_b32 v45, 0
  v_mov_b32 v46, 0
  v_mov_b32 v47, 0
  v_mov_b32 v48, 0
  v_mov_b32 v49, 0
  v_mov_b32 v50, 0
  v_mov_b32 v51, 0
  v_mov_b32 v52, 0
  v_mov_b32 v53, 0
  v_mov_b32 v54, 0
  v_mov_b32 v55, 0
  v_mov_b32 v56, 0
  v_mov_b32 v57, 0
  v_mov_b32 v58, 0
  v_mov_b32 v59, 0
  v_mov_b32 v60, 0
  v_mov_b32 v61, 0
  v_mov_b32 v62, 0
  v_mov_b32 v63, 0
  v_mov_b32 v64, 0
  v_mov_b32 v65, 0
  v_mov_b32 v66, 0
  v_mov_b32 v67, 0
  v_mov_b32 v68, 0
  v_mov_b32 v69, 0
  v_mov_b32 v70, 0
  v_mov_b32 v71, 0
  v_mov_b32 v3, 0xff800000
  v_mov_b32 v4, 0xff800000
  v_mov_b32 v5, 0
  v_and_b32 v8, 3, v0
  v_lshlrev_b32 v8, 8, v8
  v_bfe_u32 v9, v0, 3, 1
  v_lshl_add_u32 v8, v9, 6, v8
  v_lshrrev_b32 v9, 4, v0
  v_lshl_add_u32 v8, v9, 4, v8
  s_mov_b32 s8, 0
  s_waitcnt vmcnt(8)
  s_barrier
  s_barrier
  ds_read_b128 v[12:15], v8 offset:18688
  ds_read_b128 v[16:19], v8 offset:18816
  s_waitcnt lgkmcnt(0)
  s_mul_i32 s42, s42, 1664525
  s_add_u32 s42, s42, 1013904223
  s_or_b32 s9, s42, 0x01010101
  s_bfe_u32 s92, s9, 0x80000
  s_bfe_u32 s93, s9, 0x80008
  s_bfe_u32 s94, s9, 0x80010
  s_bfe_u32 s95, s9, 0x80018
L_loop:
  s_waitcnt vmcnt(8)
  v_readfirstlane_b32 s9, v7
  s_lshl_b32 s6, s9, 0
  s_add_u32 s6, s6, s61
  s_cmp_lt_u32 s9, 192
  s_cselect_b32 s10, s65, 0
  s_cmp_le_u32 s8, 14
  s_cbranch_scc0 L_dyn
  s_add_u32 s6, s60, s67
  s_add_u32 s60, s60, 96
  s_mov_b32 s10, s66
  s_cmp_eq_u32 s8, 0
  s_cbranch_scc0 L_dyn
  s_mov_b32 s6, s64
  s_sub_u32 s60, s60, 96
  s_mov_b32 s10, 1
L_dyn:
  s_lshl_b32 s6, s6, 13
  s_add_u32 s6, s6, s62
  s_and_b32 s6, s6, 0xffffff
  s_add_u32 s6, s6, s13
  s_add_u32 s7, s6, 4096
  s_cmp_lt_u32 s8, 4096
  s_cselect_b32 s10, s10, 0
  s_cmp_ge_u32 s8, 14
  s_cselect_b32 s63, s65, 0
  v_mfma_f32_16x16x32_bf16 v[24:27], v[72:75], v[12:15], 0
  v_mfma_f32_16x16x32_bf16 v[28:31], v[80:83], v[12:15], 0
  v_mfma_f32_16x16x32_bf16 v[32:35], v[88:91], v[12:15], 0
  v_mfma_f32_16x16x32_bf16 v[36:39], v[96:99], v[12:15], 0
  v_mfma_f32_16x16x32_bf16 v[24:27], v[76:79], v[16:19], v[24:27]
  v_mfma_f32_16x16x32_bf16 v[28:31], v[84:87], v[16:19], v[28:31]
  v_mfma_f32_16x16x32_bf16 v[32:35], v[92:95], v[16:19], v[32:35]
  v_mfma_f32_16x16x32_bf16 v[36:39], v[100:103], v[16:19], v[36:39]
  s_cmp_eq_u32 s10, 0
  s_cbranch_scc1 L_nok
  buffer_load_dwordx4 v[72:75], v1, s[48:51], s6 offen offset:0 nt
  buffer_load_dwordx4 v[76:79], v1, s[48:51], s6 offen offset:128 nt
  buffer_load_dwordx4 v[80:83], v1, s[48:51], s6 offen offset:2048 nt
  buffer_load_dwordx4 v[84:87], v1, s[48:51], s6 offen offset:2176 nt
  buffer_load_dwordx4 v[88:91], v1, s[48:51], s7 offen offset:0 nt
  buffer_load_dwordx4 v[92:95], v1, s[48:51], s7 offen offset:128 nt
  buffer_load_dwordx4 v[96:99], v1, s[48:51], s7 offen offset:2048 nt
  buffer_load_dwordx4 v[100:103], v1, s[48:51], s7 offen offset:2176 nt
  s_cmp_eq_u32 s63, 0
  s_cbranch_scc1 L_noclaim
  v_mov_b32 v7, 1
  s_mov_b64 exec, 1
  buffer_atomic_add v7, off, s[56:59], s12 sc0 sc1
  s_mov_b64 exec, -1
L_noclaim:
  s_bitcmp1_b32 s8, 0
  s_cbranch_scc1 L_vvr
  buffer_load_dwordx4 v[104:107], v2, s[52:55], s6 offen offset:0 nt
  buffer_load_dwordx4 v[108:111], v2, s[52:55], s6 offen offset:256 nt
  buffer_load_dwordx4 v[112:115], v2, s[52:55], s6 offen offset:512 nt
  buffer_load_dwordx4 v[116:119], v2, s[52:55], s6 offen offset:768 nt
  buffer_load_dwordx4 v[120:123], v2, s[52:55], s6 offen offset:2048 nt
  buffer_load_dwordx4 v[124:127], v2, s[52:55], s6 offen offset:2304 nt
  buffer_load_dwordx4 v[128:131], v2, s[52:55], s6 offen offset:2560 nt
  buffer_load_dwordx4 v[132:135], v2, s[52:55], s6 offen offset:2816 nt
  s_branch L_vdone
L_vvr:
  buffer_load_dwordx4 v[136:139], v2, s[52:55], s6 offen offset:0 nt
  buffer_load_dwordx4 v[140:143], v2, s[52:55], s6 offen offset:256 nt
  buffer_load_dwordx4 v[144:147], v2, s[52:55], s6 offen offset:512 nt
  buffer_load_dwordx4 v[148:151], v2, s[52:55], s6 offen offset:768 nt
  buffer_load_dwordx4 v[152:155], v2, s[52:55], s6 offen offset:2048 nt
  buffer_load_dwordx4 v[156:159], v2, s[52:55], s6 offen offset:2304 nt
  buffer_load_dwordx4 v[160:163], v2, s[52:55], s6 offen offset:2560 nt
  buffer_load_dwordx4 v[164:167], v2, s[52:55], s6 offen offset:2816 nt
L_vdone:
L_nok:
  s_nop 5
  v_permlane32_swap_b32 v24, v32
  v_permlane32_swap_b32 v28, v36
  v_permlane32_swap_b32 v25, v33
  v_permlane32_swap_b32 v29, v37
  v_permlane32_swap_b32 v26, v34
  v_permlane32_swap_b32 v30, v38
  v_permlane32_swap_b32 v27, v35
  v_permlane32_swap_b32 v31, v39
  v_add_f32_dpp v24, v32, v24 row_ror:8 row_mask:0xf bank_mask:0xf
  v_add_f32_dpp v28, v36, v28 row_ror:8 row_mask:0xf bank_mask:0xf
  v_add_f32_dpp v25, v33, v25 row_ror:8 row_mask:0xf bank_mask:0xf
  v_add_f32_dpp v29, v37, v29 row_ror:8 row_mask:0xf bank_mask:0xf
  v_add_f32_dpp v26, v34, v26 row_ror:8 row_mask:0xf bank_mask:0xf
  v_add_f32_dpp v30, v38, v30 row_ror:8 row_mask:0xf bank_mask:0xf
  v_add_f32_dpp v27, v35, v27 row_ror:8 row_mask:0xf bank_mask:0xf
  v_add_f32_dpp v31, v39, v31 row_ror:8 row_mask:0xf bank_mask:0xf
  v_cvt_pk_bf16_f32 v32, v24, v25
  v_cvt_pk_bf16_f32 v33, v26, v27
  v_cvt_pk_bf16_f32 v34, v28, v29
  v_cvt_pk_bf16_f32 v35, v30, v31
  v_lshlrev_b32 v24, 16, v32
  v_and_b32 v25, 0xffff0000, v32
  v_lshlrev_b32 v26, 16, v33
  v_and_b32 v27, 0xffff0000, v33
  v_lshlrev_b32 v28, 16, v34
  v_and_b32 v29, 0xffff0000, v34
  v_lshlrev_b32 v30, 16, v35
  v_and_b32 v31, 0xffff0000, v35
  v_pk_mul_f32 v[24:25], v[24:25], s[46:47]
  v_pk_mul_f32 v[26:27], v[26:27], s[46:47]
  v_pk_mul_f32 v[28:29], v[28:29], s[46:47]
  v_pk_mul_f32 v[30:31], v[30:31], s[46:47]
  v_cvt_pk_bf16_f32 v32, v24, v25
  v_cvt_pk_bf16_f32 v33, v26, v27
  v_cvt_pk_bf16_f32 v34, v28, v29
  v_cvt_pk_bf16_f32 v35, v30, v31
  v_lshlrev_b32 v24, 16, v32
  v_and_b32 v25, 0xffff0000, v32
  v_lshlrev_b32 v26, 16, v33
  v_and_b32 v27, 0xffff0000, v33
  v_lshlrev_b32 v28, 16, v34
  v_and_b32 v29, 0xffff0000, v34
  v_lshlrev_b32 v30, 16, v35
  v_and_b32 v31, 0xffff0000, v35
  v_max3_f32 v8, v24, v25, v26
  v_max3_f32 v9, v27, v28, v29
  v_max3_f32 v8, v30, v31, v8
  v_max_f32 v8, v8, v9
  v_mov_b32 v9, v8
  s_nop 1
  v_permlane16_swap_b32 v9, v8
  v_max_f32 v8, v8, v9
  v_mov_b32 v9, v8
  s_nop 1
  v_permlane32_swap_b32 v9, v8
  v_max_f32 v8, v8, v9
  v_max_f32 v3, v3, v8
  v_mul_f32 v9, s43, v3
  v_sub_f32 v8, v4, v9
  v_mov_b32 v4, v9
  v_exp_f32 v6, v8
  v_fma_f32 v24, v24, s43, -v4
  v_fma_f32 v25, v25, s43, -v4
  v_fma_f32 v26, v26, s43, -v4
  v_fma_f32 v27, v27, s43, -v4
  v_fma_f32 v28, v28, s43, -v4
  v_fma_f32 v29, v29, s43, -v4
  v_fma_f32 v30, v30, s43, -v4
  v_fma_f32 v31, v31, s43, -v4
  v_exp_f32 v24, v24
  v_exp_f32 v25, v25
  v_exp_f32 v26, v26
  v_exp_f32 v27, v27
  v_exp_f32 v28, v28
  v_exp_f32 v29, v29
  v_exp_f32 v30, v30
  v_exp_f32 v31, v31
  v_pk_mul_f32 v[40:41], v[40:41], v[6:7] op_sel_hi:[1,0]
  v_pk_mul_f32 v[42:43], v[42:43], v[6:7] op_sel_hi:[1,0]
  v_pk_mul_f32 v[44:45], v[44:45], v[6:7] op_sel_hi:[1,0]
  v_pk_mul_f32 v[46:47], v[46:47], v[6:7] op_sel_hi:[1,0]
  v_pk_mul_f32 v[48:49], v[48:49], v[6:7] op_sel_hi:[1,0]
  v_pk_mul_f32 v[50:51], v[50:51], v[6:7] op_sel_hi:[1,0]
  v_pk_mul_f32 v[52:53], v[52:53], v[6:7] op_sel_hi:[1,0]
  v_pk_mul_f32 v[54:55], v[54:55], v[6:7] op_sel_hi:[1,0]
  v_pk_mul_f32 v[56:57], v[56:57], v[6:7] op_sel_hi:[1,0]
  v_pk_mul_f32 v[58:59], v[58:59], v[6:7] op_sel_hi:[1,0]
  v_pk_mul_f32 v[60:61], v[60:61], v[6:7] op_sel_hi:[1,0]
  v_pk_mul_f32 v[62:63], v[62:63], v[6:7] op_sel_hi:[1,0]
  v_pk_mul_f32 v[64:65], v[64:65], v[6:7] op_sel_hi:[1,0]
  v_pk_mul_f32 v[66:67], v[66:67], v[6:7] op_sel_hi:[1,0]
  v_pk_mul_f32 v[68:69], v[68:69], v[6:7] op_sel_hi:[1,0]
  v_pk_mul_f32 v[70:71], v[70:71], v[6:7] op_sel_hi:[1,0]
  v_cvt_pk_bf16_f32 v20, v24, v25
  v_cvt_pk_bf16_f32 v21, v26, v27
  v_cvt_pk_bf16_f32 v22, v28, v29
  v_cvt_pk_bf16_f32 v23, v30, v31
  v_pk_add_f32 v[24:25], v[24:25], v[26:27]
  v_pk_add_f32 v[28:29], v[28:29], v[30:31]
  v_pk_add_f32 v[24:25], v[24:25], v[28:29]
  v_add_f32 v24, v24, v25
  v_fma_f32 v5, v5, v6, v24
  s_cmp_eq_u32 s10, 0
  s_cbranch_scc1 L_w0
  s_cmp_eq_u32 s63, 0
  s_cbranch_scc1 L_w16
  s_waitcnt vmcnt(17)
  s_branch L_w1
L_w16:
  s_waitcnt vmcnt(16)
  s_branch L_w1
L_w0:
  s_waitcnt vmcnt(0)
L_w1:
  s_bitcmp1_b32 s8, 0
  s_cbranch_scc0 L_pvr
  v_perm_b32 v24, v108, v104, s44
  v_perm_b32 v25, v116, v112, s44
  v_perm_b32 v26, v124, v120, s44
  v_perm_b32 v27, v132, v128, s44
  v_perm_b32 v28, v108, v104, s45
  v_perm_b32 v29, v116, v112, s45
  v_perm_b32 v30, v124, v120, s45
  v_perm_b32 v31, v132, v128, s45
  v_mfma_f32_16x16x32_bf16 v[40:43], v[24:27], v[20:23], v[40:43]
  s_nop 0
  v_mfma_f32_16x16x32_bf16 v[44:47], v[28:31], v[20:23], v[44:47]
  v_perm_b32 v32, v109, v105, s44
  v_perm_b32 v33, v117, v113, s44
  v_perm_b32 v34, v125, v121, s44
  v_perm_b32 v35, v133, v129, s44
  v_perm_b32 v36, v109, v105, s45
  v_perm_b32 v37, v117, v113, s45
  v_perm_b32 v38, v125, v121, s45
  v_perm_b32 v39, v133, v129, s45
  v_mfma_f32_16x16x32_bf16 v[48:51], v[32:35], v[20:23], v[48:51]
  s_nop 0
  v_mfma_f32_16x16x32_bf16 v[52:55], v[36:39], v[20:23], v[52:55]
  v_perm_b32 v24, v110, v106, s44
  v_perm_b32 v25, v118, v114, s44
  v_perm_b32 v26, v126, v122, s44
  v_perm_b32 v27, v134, v130, s44
  v_perm_b32 v28, v110, v106, s45
  v_perm_b32 v29, v118, v114, s45
  v_perm_b32 v30, v126, v122, s45
  v_perm_b32 v31, v134, v130, s45
  v_mfma_f32_16x16x32_bf16 v[56:59], v[24:27], v[20:23], v[56:59]
  s_nop 0
  v_mfma_f32_16x16x32_bf16 v[60:63], v[28:31], v[20:23], v[60:63]
  v_perm_b32 v32, v111, v107, s44
  v_perm_b32 v33, v119, v115, s44
  v_perm_b32 v34, v127, v123, s44
  v_perm_b32 v35, v135, v131, s44
  v_perm_b32 v36, v111, v107, s45
  v_perm_b32 v37, v119, v115, s45
  v_perm_b32 v38, v127, v123, s45
  v_perm_b32 v39, v135, v131, s45
  v_mfma_f32_16x16x32_bf16 v[64:67], v[32:35], v[20:23], v[64:67]
  s_nop 0
  v_mfma_f32_16x16x32_bf16 v[68:71], v[36:39], v[20:23], v[68:71]
  s_branch L_pvd
L_pvr:
  v_perm_b32 v24, v140, v136, s44
  v_perm_b32 v25, v148, v144, s44
  v_perm_b32 v26, v156, v152, s44
  v_perm_b32 v27, v164, v160, s44
  v_perm_b32 v28, v140, v136, s45
  v_perm_b32 v29, v148, v144, s45
  v_perm_b32 v30, v156, v152, s45
  v_perm_b32 v31, v164, v160, s45
  v_mfma_f32_16x16x32_bf16 v[40:43], v[24:27], v[20:23], v[40:43]
  s_nop 0
  v_mfma_f32_16x16x32_bf16 v[44:47], v[28:31], v[20:23], v[44:47]
  v_perm_b32 v32, v141, v137, s44
  v_perm_b32 v33, v149, v145, s44
  v_perm_b32 v34, v157, v153, s44
  v_perm_b32 v35, v165, v161, s44
  v_perm_b32 v36, v141, v137, s45
  v_perm_b32 v37, v149, v145, s45
  v_perm_b32 v38, v157, v153, s45
  v_perm_b32 v39, v165, v161, s45
  v_mfma_f32_16x16x32_bf16 v[48:51], v[32:35], v[20:23], v[48:51]
  s_nop 0
  v_mfma_f32_16x16x32_bf16 v[52:55], v[36:39], v[20:23], v[52:55]
  v_perm_b32 v24, v142, v138, s44
  v_perm_b32 v25, v150, v146, s44
  v_perm_b32 v26, v158, v154, s44
  v_perm_b32 v27, v166, v162, s44
  v_perm_b32 v28, v142, v138, s45
  v_perm_b32 v29, v150, v146, s45
  v_perm_b32 v30, v158, v154, s45
  v_perm_b32 v31, v166, v162, s45
  v_mfma_f32_16x16x32_bf16 v[56:59], v[24:27], v[20:23], v[56:59]
  s_nop 0
  v_mfma_f32_16x16x32_bf16 v[60:63], v[28:31], v[20:23], v[60:63]
  v_perm_b32 v32, v143, v139, s44
  v_perm_b32 v33, v151, v147, s44
  v_perm_b32 v34, v159, v155, s44
  v_perm_b32 v35, v167, v163, s44
  v_perm_b32 v36, v143, v139, s45
  v_perm_b32 v37, v151, v147, s45
  v_perm_b32 v38, v159, v155, s45
  v_perm_b32 v39, v167, v163, s45
  v_mfma_f32_16x16x32_bf16 v[64:67], v[32:35], v[20:23], v[64:67]
  s_nop 0
  v_mfma_f32_16x16x32_bf16 v[68:71], v[36:39], v[20:23], v[68:71]
L_pvd:
  s_cmp_eq_u32 s10, 0
  s_cbranch_scc1 L_done
  s_add_u32 s8, s8, 1
  s_branch L_loop
L_done:
  v_mov_b32 v9, v5
  s_nop 1
  v_permlane16_swap_b32 v9, v5
  v_add_f32 v5, v5, v9
  v_mov_b32 v9, v5
  s_nop 1
  v_permlane32_swap_b32 v9, v5
  v_add_f32 v5, v5, v9
  v_and_b32 v8, 3, v0
  v_lshlrev_b32 v8, 6, v8
  v_lshrrev_b32 v9, 4, v0
  v_lshl_add_u32 v8, v9, 4, v8
  s_mul_i32 s9, s3, 2304
  v_add_u32 v8, s9, v8
  v_and_b32 v10, 3, v0
  v_lshlrev_b32 v10, 3, v10
  s_lshl_b32 s9, s3, 5
  v_add_u32 v10, s9, v10
  v_mov_b32 v24, v3
  v_mov_b32 v25, v5
  s_mov_b32 exec_lo, 0x000f000f
  s_mov_b32 exec_hi, 0x000f000f
  ds_write_b128 v8, v[40:43] offset:0
  ds_write_b128 v8, v[44:47] offset:288
  ds_write_b128 v8, v[48:51] offset:576
  ds_write_b128 v8, v[52:55] offset:864
  ds_write_b128 v8, v[56:59] offset:1152
  ds_write_b128 v8, v[60:63] offset:1440
  ds_write_b128 v8, v[64:67] offset:1728
  ds_write_b128 v8, v[68:71] offset:2016
  s_mov_b32 exec_lo, 0xf
  s_mov_b32 exec_hi, 0
  ds_write_b64 v10, v[24:25] offset:18432
  s_mov_b64 exec, -1
  v_and_b32 v8, 7, v0
  v_mul_u32_u24 v8, 288, v8
  v_lshrrev_b32 v9, 3, v0
  v_lshl_add_u32 v8, v9, 4, v8
  s_lshl_b32 s9, s3, 7
  v_add_u32 v8, s9, v8
  v_lshrrev_b32 v9, 5, v0
  v_lshlrev_b32 v10, 3, v9
  s_lshl_b32 s9, s3, 4
  v_add_u32 v10, s9, v10
  v_lshlrev_b32 v11, 9, v9
  v_lshlrev_b32 v9, 4, v0
  s_lshl_b32 s9, s2, 11
  s_lshl_b32 s10, s3, 10
  s_add_u32 s9, s9, s10
  s_add_u32 s9, s9, 0x100000
  s_lshl_b32 s10, s4, 2
  s_lshl_b32 s13, s3, 1
  s_add_u32 s10, s10, s13
  s_lshl_b32 s10, s10, 9
  s_lshl_b32 s13, s5, 4
  s_add_u32 s10, s10, s13
  s_add_u32 s10, s10, 0x200000
  s_waitcnt lgkmcnt(0)
  s_barrier
  s_cmp_ge_u32 s3, 2
  s_cbranch_scc1 L_end
  ds_read_b64 v[72:73], v10 offset:18432
  ds_read_b64 v[74:75], v10 offset:18464
  ds_read_b64 v[76:77], v10 offset:18496
  ds_read_b64 v[78:79], v10 offset:18528
  ds_read_b64 v[80:81], v10 offset:18560
  ds_read_b64 v[82:83], v10 offset:18592
  ds_read_b64 v[84:85], v10 offset:18624
  ds_read_b64 v[86:87], v10 offset:18656
  ds_read_b128 v[88:91], v8 offset:0
  ds_read_b128 v[92:95], v8 offset:2304
  ds_read_b128 v[96:99], v8 offset:4608
  ds_read_b128 v[100:103], v8 offset:6912
  ds_read_b128 v[104:107], v8 offset:9216
  ds_read_b128 v[108:111], v8 offset:11520
  ds_read_b128 v[112:115], v8 offset:13824
  ds_read_b128 v[116:119], v8 offset:16128
  s_waitcnt lgkmcnt(8)
  v_max3_f32 v24, v72, v74, v76
  v_max3_f32 v25, v78, v80, v82
  v_max3_f32 v24, v84, v86, v24
  v_max_f32 v24, v24, v25
  v_sub_f32 v72, v72, v24
  v_sub_f32 v74, v74, v24
  v_sub_f32 v76, v76, v24
  v_sub_f32 v78, v78, v24
  v_sub_f32 v80, v80, v24
  v_sub_f32 v82, v82, v24
  v_sub_f32 v84, v84, v24
  v_sub_f32 v86, v86, v24
  v_mul_f32 v72, s43, v72
  v_mul_f32 v74, s43, v74
  v_mul_f32 v76, s43, v76
  v_mul_f32 v78, s43, v78
  v_mul_f32 v80, s43, v80
  v_mul_f32 v82, s43, v82
  v_mul_f32 v84, s43, v84
  v_mul_f32 v86, s43, v86
  v_exp_f32 v72, v72
  v_exp_f32 v74, v74
  v_exp_f32 v76, v76
  v_exp_f32 v78, v78
  v_exp_f32 v80, v80
  v_exp_f32 v82, v82
  v_exp_f32 v84, v84
  v_exp_f32 v86, v86
  v_mul_f32 v25, v72, v73
  v_fmac_f32 v25, v74, v75
  v_fmac_f32 v25, v76, v77
  v_fmac_f32 v25, v78, v79
  v_fmac_f32 v25, v80, v81
  v_fmac_f32 v25, v82, v83
  v_fmac_f32 v25, v84, v85
  v_fmac_f32 v25, v86, v87
  v_mov_b32 v26, s42
  v_mov_b32 v27, s42
  s_mov_b32 exec_lo, 1
  s_mov_b32 exec_hi, 1
  buffer_store_dwordx4 v[24:27], v11, s[56:59], s10 offen sc1
  s_mov_b64 exec, -1
  s_waitcnt lgkmcnt(7)
  v_mul_f32 v28, v72, v88
  v_mul_f32 v29, v72, v89
  v_mul_f32 v30, v72, v90
  v_mul_f32 v31, v72, v91
  s_waitcnt lgkmcnt(6)
  v_fmac_f32 v28, v74, v92
  v_fmac_f32 v29, v74, v93
  v_fmac_f32 v30, v74, v94
  v_fmac_f32 v31, v74, v95
  s_waitcnt lgkmcnt(5)
  v_fmac_f32 v28, v76, v96
  v_fmac_f32 v29, v76, v97
  v_fmac_f32 v30, v76, v98
  v_fmac_f32 v31, v76, v99
  s_waitcnt lgkmcnt(4)
  v_fmac_f32 v28, v78, v100
  v_fmac_f32 v29, v78, v101
  v_fmac_f32 v30, v78, v102
  v_fmac_f32 v31, v78, v103
  s_waitcnt lgkmcnt(3)
  v_fmac_f32 v28, v80, v104
  v_fmac_f32 v29, v80, v105
  v_fmac_f32 v30, v80, v106
  v_fmac_f32 v31, v80, v107
  s_waitcnt lgkmcnt(2)
  v_fmac_f32 v28, v82, v108
  v_fmac_f32 v29, v82, v109
  v_fmac_f32 v30, v82, v110
  v_fmac_f32 v31, v82, v111
  s_waitcnt lgkmcnt(1)
  v_fmac_f32 v28, v84, v112
  v_fmac_f32 v29, v84, v113
  v_fmac_f32 v30, v84, v114
  v_fmac_f32 v31, v84, v115
  s_waitcnt lgkmcnt(0)
  v_fmac_f32 v28, v86, v116
  v_fmac_f32 v29, v86, v117
  v_fmac_f32 v30, v86, v118
  v_fmac_f32 v31, v86, v119
  v_and_b32 v28, 0xffffff00, v28
  v_and_b32 v29, 0xffffff00, v29
  v_and_b32 v30, 0xffffff00, v30
  v_and_b32 v31, 0xffffff00, v31
  v_or_b32 v28, s92, v28
  v_or_b32 v29, s93, v29
  v_or_b32 v30, s94, v30
  v_or_b32 v31, s95, v31
  buffer_store_dwordx4 v[28:31], v9, s[56:59], s9 offen sc1
  s_endpgm
L_service:
  s_setprio 3
  s_mov_b32 s99, 0
  v_lshlrev_b32 v1, 4, v0
  v_lshrrev_b32 v2, 3, v0
  v_lshlrev_b32 v2, 13, v2
  v_and_b32 v3, 7, v0
  v_lshl_add_u32 v2, v3, 4, v2
  s_and_b32 s98, s5, 7
  s_lshr_b32 s97, s5, 3
  s_lshl_b32 s6, s4, 10
  s_lshl_b32 s7, s98, 7
  s_add_u32 s6, s6, s7
  s_lshl_b32 s7, s97, 20
  s_add_u32 s6, s6, s7
  s_waitcnt lgkmcnt(0)
  s_load_dword s42, s[40:41], 0
  s_mov_b32 s56, s40
  s_mov_b32 s57, s41
  s_mov_b32 s58, 0x400000
  s_mov_b32 s59, 0x20000
  s_and_b32 s9, s5, 31
  s_cmp_lg_u32 s9, 0
  s_cbranch_scc1 L_notk
  s_lshr_b32 s9, s5, 5
  s_lshl_b32 s9, s9, 3
  s_add_u32 s9, s9, s4
  s_mul_i32 s9, s9, 256
  s_add_u32 s9, s9, 0x8000
  v_mov_b32 v8, 0
  s_mov_b64 exec, 1
  buffer_store_dword v8, off, s[56:59], s9 sc1
  s_mov_b64 exec, -1
L_notk:
  s_mov_b32 s48, s16
  s_mov_b32 s49, s17
  s_mov_b32 s50, 0x400
  s_mov_b32 s51, 0x20000
  s_mov_b32 s52, s22
  s_mov_b32 s53, s23
  s_mov_b32 s54, 0x400000
  s_mov_b32 s55, 0x20000
  buffer_load_dwordx4 v[24:27], v1, s[48:51], 0 offen
  buffer_load_dwordx4 v[32:35], v2, s[52:55], s6 offen nt
  s_add_u32 s6, s6, 0x10000
  buffer_load_dwordx4 v[36:39], v2, s[52:55], s6 offen nt
  s_add_u32 s6, s6, 0x10000
  buffer_load_dwordx4 v[40:43], v2, s[52:55], s6 offen nt
  s_add_u32 s6, s6, 0x10000
  buffer_load_dwordx4 v[44:47], v2, s[52:55], s6 offen nt
  s_add_u32 s6, s6, 0x10000
  buffer_load_dwordx4 v[48:51], v2, s[52:55], s6 offen nt
  s_add_u32 s6, s6, 0x10000
  buffer_load_dwordx4 v[52:55], v2, s[52:55], s6 offen nt
  s_add_u32 s6, s6, 0x10000
  buffer_load_dwordx4 v[56:59], v2, s[52:55], s6 offen nt
  s_add_u32 s6, s6, 0x10000
  buffer_load_dwordx4 v[60:63], v2, s[52:55], s6 offen nt
  s_add_u32 s6, s6, 0x10000
  buffer_load_dwordx4 v[64:67], v2, s[52:55], s6 offen nt
  s_add_u32 s6, s6, 0x10000
  buffer_load_dwordx4 v[68:71], v2, s[52:55], s6 offen nt
  s_add_u32 s6, s6, 0x10000
  buffer_load_dwordx4 v[72:75], v2, s[52:55], s6 offen nt
  s_add_u32 s6, s6, 0x10000
  buffer_load_dwordx4 v[76:79], v2, s[52:55], s6 offen nt
  s_add_u32 s6, s6, 0x10000
  buffer_load_dwordx4 v[80:83], v2, s[52:55], s6 offen nt
  s_add_u32 s6, s6, 0x10000
  buffer_load_dwordx4 v[84:87], v2, s[52:55], s6 offen nt
  s_add_u32 s6, s6, 0x10000
  buffer_load_dwordx4 v[88:91], v2, s[52:55], s6 offen nt
  s_add_u32 s6, s6, 0x10000
  buffer_load_dwordx4 v[92:95], v2, s[52:55], s6 offen nt
  s_barrier
  s_mov_b32 s60, s28
  s_mov_b32 s61, s29
  s_mov_b32 s62, 0x400
  s_mov_b32 s63, 0x20000
  s_mov_b32 s64, s30
  s_mov_b32 s65, s31
  s_mov_b32 s66, 0x1c0000
  s_mov_b32 s67, 0x20000
  s_mov_b32 s68, s32
  s_mov_b32 s69, s33
  s_mov_b32 s70, 0x1c0000
  s_mov_b32 s71, 0x20000
  s_mov_b32 s72, s34
  s_mov_b32 s73, s35
  s_mov_b32 s74, 0x1c0000
  s_mov_b32 s75, 0x20000
  s_mov_b32 s76, s24
  s_mov_b32 s77, s25
  s_mov_b32 s78, 0x400000
  s_mov_b32 s79, 0x20000
  s_mov_b32 s80, s36
  s_mov_b32 s81, s37
  s_mov_b32 s82, 0x400
  s_mov_b32 s83, 0x20000
  s_waitcnt vmcnt(16)
  v_lshlrev_b32 v8, 16, v24
  v_and_b32 v9, 0xffff0000, v24
  v_lshlrev_b32 v10, 16, v25
  v_and_b32 v11, 0xffff0000, v25
  v_lshlrev_b32 v12, 16, v26
  v_and_b32 v13, 0xffff0000, v26
  v_lshlrev_b32 v14, 16, v27
  v_and_b32 v15, 0xffff0000, v27
  v_add_f32 v4, v8, v9
  v_add_f32 v4, v4, v10
  v_add_f32 v4, v4, v11
  v_add_f32 v4, v4, v12
  v_add_f32 v4, v4, v13
  v_add_f32 v4, v4, v14
  v_add_f32 v4, v4, v15
  s_nop 1
  v_add_f32_dpp v4, v4, v4 row_ror:1 row_mask:0xf bank_mask:0xf
  s_nop 1
  v_add_f32_dpp v4, v4, v4 row_ror:2 row_mask:0xf bank_mask:0xf
  s_nop 1
  v_add_f32_dpp v4, v4, v4 row_ror:4 row_mask:0xf bank_mask:0xf
  s_nop 1
  v_add_f32_dpp v4, v4, v4 row_ror:8 row_mask:0xf bank_mask:0xf
  v_mov_b32 v5, v4
  s_nop 1
  v_permlane16_swap_b32 v5, v4
  v_add_f32 v4, v4, v5
  v_mov_b32 v5, v4
  s_nop 1
  v_permlane32_swap_b32 v5, v4
  v_add_f32 v4, v4, v5
  v_mul_f32 v4, 0x3b000000, v4
  v_sub_f32 v16, v8, v4
  v_sub_f32 v17, v9, v4
  v_sub_f32 v18, v10, v4
  v_sub_f32 v19, v11, v4
  v_sub_f32 v20, v12, v4
  v_sub_f32 v21, v13, v4
  v_sub_f32 v22, v14, v4
  v_sub_f32 v23, v15, v4
  v_mul_f32 v6, v16, v16
  v_fmac_f32 v6, v17, v17
  v_fmac_f32 v6, v18, v18
  v_fmac_f32 v6, v19, v19
  v_fmac_f32 v6, v20, v20
  v_fmac_f32 v6, v21, v21
  v_fmac_f32 v6, v22, v22
  v_fmac_f32 v6, v23, v23
  s_nop 1
  v_add_f32_dpp v6, v6, v6 row_ror:1 row_mask:0xf bank_mask:0xf
  s_nop 1
  v_add_f32_dpp v6, v6, v6 row_ror:2 row_mask:0xf bank_mask:0xf
  s_nop 1
  v_add_f32_dpp v6, v6, v6 row_ror:4 row_mask:0xf bank_mask:0xf
  s_nop 1
  v_add_f32_dpp v6, v6, v6 row_ror:8 row_mask:0xf bank_mask:0xf
  v_mov_b32 v5, v6
  s_nop 1
  v_permlane16_swap_b32 v5, v6
  v_add_f32 v6, v6, v5
  v_mov_b32 v5, v6
  s_nop 1
  v_permlane32_swap_b32 v5, v6
  v_add_f32 v6, v6, v5
  v_mul_f32 v6, 0x3b000000, v6
  v_cvt_pk_bf16_f32 v5, v4, v6
  v_lshlrev_b32 v4, 16, v5
  v_and_b32 v6, 0xffff0000, v5
  v_add_f32 v6, 0x3727c5ac, v6
  v_cvt_pk_bf16_f32 v5, v6, v6
  v_lshlrev_b32 v6, 16, v5
  v_sqrt_f32 v6, v6
  s_nop 0
  v_cvt_pk_bf16_f32 v5, v6, v6
  v_lshlrev_b32 v6, 16, v5
  v_rcp_f32 v7, v6
  v_sub_f32 v16, v8, v4
  v_sub_f32 v17, v9, v4
  v_sub_f32 v18, v10, v4
  v_sub_f32 v19, v11, v4
  v_sub_f32 v20, v12, v4
  v_sub_f32 v21, v13, v4
  v_sub_f32 v22, v14, v4
  v_sub_f32 v23, v15, v4
  v_cvt_pk_bf16_f32 v28, v16, v17
  v_cvt_pk_bf16_f32 v29, v18, v19
  v_cvt_pk_bf16_f32 v30, v20, v21
  v_cvt_pk_bf16_f32 v31, v22, v23
  v_lshlrev_b32 v16, 16, v28
  v_and_b32 v17, 0xffff0000, v28
  v_lshlrev_b32 v18, 16, v29
  v_and_b32 v19, 0xffff0000, v29
  v_lshlrev_b32 v20, 16, v30
  v_and_b32 v21, 0xffff0000, v30
  v_lshlrev_b32 v22, 16, v31
  v_and_b32 v23, 0xffff0000, v31
  v_mul_f32 v96, v16, v7
  v_mul_f32 v97, v17, v7
  v_mul_f32 v98, v18, v7
  v_mul_f32 v99, v19, v7
  v_mul_f32 v100, v20, v7
  v_mul_f32 v101, v21, v7
  v_mul_f32 v102, v22, v7
  v_mul_f32 v103, v23, v7
  v_fma_f32 v16, -v96, v6, v16
  v_fma_f32 v17, -v97, v6, v17
  v_fma_f32 v18, -v98, v6, v18
  v_fma_f32 v19, -v99, v6, v19
  v_fma_f32 v20, -v100, v6, v20
  v_fma_f32 v21, -v101, v6, v21
  v_fma_f32 v22, -v102, v6, v22
  v_fma_f32 v23, -v103, v6, v23
  v_fma_f32 v16, v16, v7, v96
  v_fma_f32 v17, v17, v7, v97
  v_fma_f32 v18, v18, v7, v98
  v_fma_f32 v19, v19, v7, v99
  v_fma_f32 v20, v20, v7, v100
  v_fma_f32 v21, v21, v7, v101
  v_fma_f32 v22, v22, v7, v102
  v_fma_f32 v23, v23, v7, v103
  v_cvt_pk_bf16_f32 v28, v16, v17
  v_cvt_pk_bf16_f32 v29, v18, v19
  v_cvt_pk_bf16_f32 v30, v20, v21
  v_cvt_pk_bf16_f32 v31, v22, v23
  v_lshlrev_b32 v16, 16, v28
  v_and_b32 v17, 0xffff0000, v28
  v_lshlrev_b32 v18, 16, v29
  v_and_b32 v19, 0xffff0000, v29
  v_lshlrev_b32 v20, 16, v30
  v_and_b32 v21, 0xffff0000, v30
  v_lshlrev_b32 v22, 16, v31
  v_and_b32 v23, 0xffff0000, v31
  v_lshlrev_b32 v4, 5, v0
  ds_write_b128 v4, v[16:19] offset:19712
  ds_write_b128 v4, v[20:23] offset:19728
  v_add_f32 v8, v8, v16
  v_add_f32 v9, v9, v17
  v_add_f32 v10, v10, v18
  v_add_f32 v11, v11, v19
  v_add_f32 v12, v12, v20
  v_add_f32 v13, v13, v21
  v_add_f32 v14, v14, v22
  v_add_f32 v15, v15, v23
  ds_write_b128 v4, v[8:11] offset:21760
  ds_write_b128 v4, v[12:15] offset:21776
  v_lshrrev_b32 v5, 3, v0
  v_lshlrev_b32 v5, 2, v5
  s_lshl_b32 s7, s97, 9
  v_add_u32 v5, s7, v5
  s_waitcnt lgkmcnt(0)
  ds_read_b32 v96, v5 offset:19712
  ds_read_b32 v97, v5 offset:19744
  ds_read_b32 v98, v5 offset:19776
  ds_read_b32 v99, v5 offset:19808
  ds_read_b32 v100, v5 offset:19840
  ds_read_b32 v101, v5 offset:19872
  ds_read_b32 v102, v5 offset:19904
  ds_read_b32 v103, v5 offset:19936
  ds_read_b32 v104, v5 offset:19968
  ds_read_b32 v105, v5 offset:20000
  ds_read_b32 v106, v5 offset:20032
  ds_read_b32 v107, v5 offset:20064
  ds_read_b32 v108, v5 offset:20096
  ds_read_b32 v109, v5 offset:20128
  ds_read_b32 v110, v5 offset:20160
  ds_read_b32 v111, v5 offset:20192
  v_mov_b32 v8, 0
  v_mov_b32 v9, 0
  v_mov_b32 v10, 0
  v_mov_b32 v11, 0
  v_mov_b32 v12, 0
  v_mov_b32 v13, 0
  v_mov_b32 v14, 0
  v_mov_b32 v15, 0
  s_waitcnt lgkmcnt(0)
  s_waitcnt vmcnt(15)
  v_lshrrev_b32 v28, 16, v96
  v_dot2c_f32_bf16 v8, v32, v28
  v_dot2c_f32_bf16 v9, v32, v96
  v_dot2c_f32_bf16 v10, v33, v28
  v_dot2c_f32_bf16 v11, v33, v96
  v_dot2c_f32_bf16 v12, v34, v28
  v_dot2c_f32_bf16 v13, v34, v96
  v_dot2c_f32_bf16 v14, v35, v28
  v_dot2c_f32_bf16 v15, v35, v96
  s_waitcnt vmcnt(14)
  v_lshrrev_b32 v28, 16, v97
  v_dot2c_f32_bf16 v8, v36, v28
  v_dot2c_f32_bf16 v9, v36, v97
  v_dot2c_f32_bf16 v10, v37, v28
  v_dot2c_f32_bf16 v11, v37, v97
  v_dot2c_f32_bf16 v12, v38, v28
  v_dot2c_f32_bf16 v13, v38, v97
  v_dot2c_f32_bf16 v14, v39, v28
  v_dot2c_f32_bf16 v15, v39, v97
  s_waitcnt vmcnt(13)
  v_lshrrev_b32 v28, 16, v98
  v_dot2c_f32_bf16 v8, v40, v28
  v_dot2c_f32_bf16 v9, v40, v98
  v_dot2c_f32_bf16 v10, v41, v28
  v_dot2c_f32_bf16 v11, v41, v98
  v_dot2c_f32_bf16 v12, v42, v28
  v_dot2c_f32_bf16 v13, v42, v98
  v_dot2c_f32_bf16 v14, v43, v28
  v_dot2c_f32_bf16 v15, v43, v98
  s_waitcnt vmcnt(12)
  v_lshrrev_b32 v28, 16, v99
  v_dot2c_f32_bf16 v8, v44, v28
  v_dot2c_f32_bf16 v9, v44, v99
  v_dot2c_f32_bf16 v10, v45, v28
  v_dot2c_f32_bf16 v11, v45, v99
  v_dot2c_f32_bf16 v12, v46, v28
  v_dot2c_f32_bf16 v13, v46, v99
  v_dot2c_f32_bf16 v14, v47, v28
  v_dot2c_f32_bf16 v15, v47, v99
  s_waitcnt vmcnt(11)
  v_lshrrev_b32 v28, 16, v100
  v_dot2c_f32_bf16 v8, v48, v28
  v_dot2c_f32_bf16 v9, v48, v100
  v_dot2c_f32_bf16 v10, v49, v28
  v_dot2c_f32_bf16 v11, v49, v100
  v_dot2c_f32_bf16 v12, v50, v28
  v_dot2c_f32_bf16 v13, v50, v100
  v_dot2c_f32_bf16 v14, v51, v28
  v_dot2c_f32_bf16 v15, v51, v100
  s_waitcnt vmcnt(10)
  v_lshrrev_b32 v28, 16, v101
  v_dot2c_f32_bf16 v8, v52, v28
  v_dot2c_f32_bf16 v9, v52, v101
  v_dot2c_f32_bf16 v10, v53, v28
  v_dot2c_f32_bf16 v11, v53, v101
  v_dot2c_f32_bf16 v12, v54, v28
  v_dot2c_f32_bf16 v13, v54, v101
  v_dot2c_f32_bf16 v14, v55, v28
  v_dot2c_f32_bf16 v15, v55, v101
  s_waitcnt vmcnt(9)
  v_lshrrev_b32 v28, 16, v102
  v_dot2c_f32_bf16 v8, v56, v28
  v_dot2c_f32_bf16 v9, v56, v102
  v_dot2c_f32_bf16 v10, v57, v28
  v_dot2c_f32_bf16 v11, v57, v102
  v_dot2c_f32_bf16 v12, v58, v28
  v_dot2c_f32_bf16 v13, v58, v102
  v_dot2c_f32_bf16 v14, v59, v28
  v_dot2c_f32_bf16 v15, v59, v102
  s_waitcnt vmcnt(8)
  v_lshrrev_b32 v28, 16, v103
  v_dot2c_f32_bf16 v8, v60, v28
  v_dot2c_f32_bf16 v9, v60, v103
  v_dot2c_f32_bf16 v10, v61, v28
  v_dot2c_f32_bf16 v11, v61, v103
  v_dot2c_f32_bf16 v12, v62, v28
  v_dot2c_f32_bf16 v13, v62, v103
  v_dot2c_f32_bf16 v14, v63, v28
  v_dot2c_f32_bf16 v15, v63, v103
  s_waitcnt vmcnt(7)
  v_lshrrev_b32 v28, 16, v104
  v_dot2c_f32_bf16 v8, v64, v28
  v_dot2c_f32_bf16 v9, v64, v104
  v_dot2c_f32_bf16 v10, v65, v28
  v_dot2c_f32_bf16 v11, v65, v104
  v_dot2c_f32_bf16 v12, v66, v28
  v_dot2c_f32_bf16 v13, v66, v104
  v_dot2c_f32_bf16 v14, v67, v28
  v_dot2c_f32_bf16 v15, v67, v104
  s_waitcnt vmcnt(6)
  v_lshrrev_b32 v28, 16, v105
  v_dot2c_f32_bf16 v8, v68, v28
  v_dot2c_f32_bf16 v9, v68, v105
  v_dot2c_f32_bf16 v10, v69, v28
  v_dot2c_f32_bf16 v11, v69, v105
  v_dot2c_f32_bf16 v12, v70, v28
  v_dot2c_f32_bf16 v13, v70, v105
  v_dot2c_f32_bf16 v14, v71, v28
  v_dot2c_f32_bf16 v15, v71, v105
  s_waitcnt vmcnt(5)
  v_lshrrev_b32 v28, 16, v106
  v_dot2c_f32_bf16 v8, v72, v28
  v_dot2c_f32_bf16 v9, v72, v106
  v_dot2c_f32_bf16 v10, v73, v28
  v_dot2c_f32_bf16 v11, v73, v106
  v_dot2c_f32_bf16 v12, v74, v28
  v_dot2c_f32_bf16 v13, v74, v106
  v_dot2c_f32_bf16 v14, v75, v28
  v_dot2c_f32_bf16 v15, v75, v106
  s_waitcnt vmcnt(4)
  v_lshrrev_b32 v28, 16, v107
  v_dot2c_f32_bf16 v8, v76, v28
  v_dot2c_f32_bf16 v9, v76, v107
  v_dot2c_f32_bf16 v10, v77, v28
  v_dot2c_f32_bf16 v11, v77, v107
  v_dot2c_f32_bf16 v12, v78, v28
  v_dot2c_f32_bf16 v13, v78, v107
  v_dot2c_f32_bf16 v14, v79, v28
  v_dot2c_f32_bf16 v15, v79, v107
  s_waitcnt vmcnt(3)
  v_lshrrev_b32 v28, 16, v108
  v_dot2c_f32_bf16 v8, v80, v28
  v_dot2c_f32_bf16 v9, v80, v108
  v_dot2c_f32_bf16 v10, v81, v28
  v_dot2c_f32_bf16 v11, v81, v108
  v_dot2c_f32_bf16 v12, v82, v28
  v_dot2c_f32_bf16 v13, v82, v108
  v_dot2c_f32_bf16 v14, v83, v28
  v_dot2c_f32_bf16 v15, v83, v108
  s_waitcnt vmcnt(2)
  v_lshrrev_b32 v28, 16, v109
  v_dot2c_f32_bf16 v8, v84, v28
  v_dot2c_f32_bf16 v9, v84, v109
  v_dot2c_f32_bf16 v10, v85, v28
  v_dot2c_f32_bf16 v11, v85, v109
  v_dot2c_f32_bf16 v12, v86, v28
  v_dot2c_f32_bf16 v13, v86, v109
  v_dot2c_f32_bf16 v14, v87, v28
  v_dot2c_f32_bf16 v15, v87, v109
  s_waitcnt vmcnt(1)
  v_lshrrev_b32 v28, 16, v110
  v_dot2c_f32_bf16 v8, v88, v28
  v_dot2c_f32_bf16 v9, v88, v110
  v_dot2c_f32_bf16 v10, v89, v28
  v_dot2c_f32_bf16 v11, v89, v110
  v_dot2c_f32_bf16 v12, v90, v28
  v_dot2c_f32_bf16 v13, v90, v110
  v_dot2c_f32_bf16 v14, v91, v28
  v_dot2c_f32_bf16 v15, v91, v110
  s_waitcnt vmcnt(0)
  v_lshrrev_b32 v28, 16, v111
  v_dot2c_f32_bf16 v8, v92, v28
  v_dot2c_f32_bf16 v9, v92, v111
  v_dot2c_f32_bf16 v10, v93, v28
  v_dot2c_f32_bf16 v11, v93, v111
  v_dot2c_f32_bf16 v12, v94, v28
  v_dot2c_f32_bf16 v13, v94, v111
  v_dot2c_f32_bf16 v14, v95, v28
  v_dot2c_f32_bf16 v15, v95, v111
  v_add_f32_dpp v8, v8, v8 row_ror:8 row_mask:0xf bank_mask:0xf
  v_add_f32_dpp v9, v9, v9 row_ror:8 row_mask:0xf bank_mask:0xf
  v_add_f32_dpp v10, v10, v10 row_ror:8 row_mask:0xf bank_mask:0xf
  v_add_f32_dpp v11, v11, v11 row_ror:8 row_mask:0xf bank_mask:0xf
  v_add_f32_dpp v12, v12, v12 row_ror:8 row_mask:0xf bank_mask:0xf
  v_add_f32_dpp v13, v13, v13 row_ror:8 row_mask:0xf bank_mask:0xf
  v_add_f32_dpp v14, v14, v14 row_ror:8 row_mask:0xf bank_mask:0xf
  v_add_f32_dpp v15, v15, v15 row_ror:8 row_mask:0xf bank_mask:0xf
  v_mov_b32 v112, v8
  v_mov_b32 v113, v9
  v_mov_b32 v114, v10
  v_mov_b32 v115, v11
  v_mov_b32 v116, v12
  v_mov_b32 v117, v13
  v_mov_b32 v118, v14
  v_mov_b32 v119, v15
  v_permlane16_swap_b32 v112, v8
  v_permlane16_swap_b32 v113, v9
  v_permlane16_swap_b32 v114, v10
  v_permlane16_swap_b32 v115, v11
  v_permlane16_swap_b32 v116, v12
  v_permlane16_swap_b32 v117, v13
  v_permlane16_swap_b32 v118, v14
  v_permlane16_swap_b32 v119, v15
  v_add_f32 v8, v8, v112
  v_add_f32 v9, v9, v113
  v_add_f32 v10, v10, v114
  v_add_f32 v11, v11, v115
  v_add_f32 v12, v12, v116
  v_add_f32 v13, v13, v117
  v_add_f32 v14, v14, v118
  v_add_f32 v15, v15, v119
  v_mov_b32 v112, v8
  v_mov_b32 v113, v9
  v_mov_b32 v114, v10
  v_mov_b32 v115, v11
  v_mov_b32 v116, v12
  v_mov_b32 v117, v13
  v_mov_b32 v118, v14
  v_mov_b32 v119, v15
  v_permlane32_swap_b32 v112, v8
  v_permlane32_swap_b32 v113, v9
  v_permlane32_swap_b32 v114, v10
  v_permlane32_swap_b32 v115, v11
  v_permlane32_swap_b32 v116, v12
  v_permlane32_swap_b32 v117, v13
  v_permlane32_swap_b32 v118, v14
  v_permlane32_swap_b32 v119, v15
  v_add_f32 v8, v8, v112
  v_add_f32 v9, v9, v113
  v_add_f32 v10, v10, v114
  v_add_f32 v11, v11, v115
  v_add_f32 v12, v12, v116
  v_add_f32 v13, v13, v117
  v_add_f32 v14, v14, v118
  v_add_f32 v15, v15, v119
  s_waitcnt lgkmcnt(0)
  s_mul_i32 s42, s42, 1664525
  s_add_u32 s42, s42, 1013904223
  s_or_b32 s9, s42, 0x01010101
  s_bfe_u32 s16, s9, 0x80000
  s_bfe_u32 s17, s9, 0x80008
  s_bfe_u32 s18, s9, 0x80010
  s_bfe_u32 s19, s9, 0x80018
  v_and_b32 v5, 8, v0
  v_cmp_ne_u32 vcc, 0, v5
  s_nop 1
  v_cndmask_b32 v112, v8, v12, vcc
  v_cndmask_b32 v113, v9, v13, vcc
  v_cndmask_b32 v114, v10, v14, vcc
  v_cndmask_b32 v115, v11, v15, vcc
  v_and_b32 v112, 0xffffff00, v112
  v_and_b32 v113, 0xffffff00, v113
  v_and_b32 v114, 0xffffff00, v114
  v_and_b32 v115, 0xffffff00, v115
  v_or_b32 v112, s16, v112
  v_or_b32 v113, s17, v113
  v_or_b32 v114, s18, v114
  v_or_b32 v115, s19, v115
  v_and_b32 v6, 7, v0
  v_lshlrev_b32 v6, 5, v6
  v_lshl_add_u32 v5, v5, 1, v6
  s_lshl_b32 s6, s4, 13
  s_add_u32 s6, s6, 0x10000
  s_lshl_b32 s7, s97, 11
  s_lshl_b32 s9, s98, 8
  s_add_u32 s7, s7, s9
  s_add_u32 s7, s7, s6
  s_mov_b64 exec, 0xffff
  buffer_store_dwordx4 v[112:115], v5, s[56:59], s7 offen sc1
  s_mov_b64 exec, -1
  v_lshlrev_b32 v5, 5, v0
  s_add_u32 s7, s6, 4096
  s_lshl_b32 s8, s97, 3
  s_add_u32 s8, s8, s4
  s_mul_i32 s8, s8, 7
  s_sub_u32 s9, s98, s4
  s_sub_u32 s9, s9, 1
  s_and_b32 s9, s9, 7
  s_add_u32 s10, s8, s9
  s_lshl_b32 s15, s4, 2
  s_add_u32 s15, s15, s97
  s_bfe_u32 s13, s5, 0x20001
  s_lshl_b32 s14, s15, 2
  s_add_u32 s14, s14, s13
  s_and_b32 s11, s5, 1
  s_cmp_lt_u32 s9, 7
  s_cselect_b32 s66, 0x1c0000, 0
  s_cselect_b32 s70, 0x1c0000, 0
  s_cmp_lt_u32 s14, 112
  s_cselect_b32 s74, 0x1c0000, 0
  v_lshrrev_b32 v8, 3, v0
  v_mul_u32_u24 v8, 3584, v8
  v_and_b32 v11, 7, v0
  v_lshl_add_u32 v8, v11, 4, v8
  v_and_b32 v9, 31, v0
  v_lshlrev_b32 v9, 4, v9
  v_lshrrev_b32 v11, 5, v0
  v_lshl_add_u32 v10, v11, 13, v9
  v_lshl_add_u32 v9, v11, 10, v9
  s_lshr_b32 s8, s10, 3
  s_and_b32 s9, s10, 7
  s_mul_i32 s12, s9, 229376
  s_lshl_b32 s13, s8, 7
  s_add_u32 s12, s12, s13
  s_lshl_b32 s20, s14, 14
  s_lshl_b32 s13, s11, 9
  s_add_u32 s20, s20, s13
  s_lshl_b32 s21, s14, 15
  s_add_u32 s21, s21, s13
  s_barrier
  buffer_load_dwordx4 v[32:35], v5, s[56:59], s6 offen offset:0 sc1
  buffer_load_dwordx4 v[36:39], v5, s[56:59], s6 offen offset:16 sc1
  buffer_load_dwordx4 v[40:43], v5, s[56:59], s6 offen offset:2048 sc1
  buffer_load_dwordx4 v[44:47], v5, s[56:59], s6 offen offset:2064 sc1
  buffer_load_dwordx4 v[48:51], v5, s[56:59], s7 offen offset:0 sc1
  buffer_load_dwordx4 v[52:55], v5, s[56:59], s7 offen offset:16 sc1
  buffer_load_dwordx4 v[56:59], v5, s[56:59], s7 offen offset:2048 sc1
  buffer_load_dwordx4 v[60:63], v5, s[56:59], s7 offen offset:2064 sc1
  s_mov_b32 m0, 0x6000
  s_nop 0
  buffer_load_dwordx4 v8, s[64:67], s12 offen nt lds
  s_mov_b32 m0, 0x8000
  s_nop 0
  buffer_load_dwordx4 v8, s[68:71], s12 offen nt lds
  s_add_u32 s12, s12, 28672
  s_mov_b32 m0, 0x6400
  s_nop 0
  buffer_load_dwordx4 v8, s[64:67], s12 offen nt lds
  s_mov_b32 m0, 0x8400
  s_nop 0
  buffer_load_dwordx4 v8, s[68:71], s12 offen nt lds
  s_add_u32 s12, s12, 28672
  s_mov_b32 m0, 0x6800
  s_nop 0
  buffer_load_dwordx4 v8, s[64:67], s12 offen nt lds
  s_mov_b32 m0, 0x8800
  s_nop 0
  buffer_load_dwordx4 v8, s[68:71], s12 offen nt lds
  s_add_u32 s12, s12, 28672
  s_mov_b32 m0, 0x6c00
  s_nop 0
  buffer_load_dwordx4 v8, s[64:67], s12 offen nt lds
  s_mov_b32 m0, 0x8c00
  s_nop 0
  buffer_load_dwordx4 v8, s[68:71], s12 offen nt lds
  s_add_u32 s12, s12, 28672
  s_mov_b32 m0, 0x7000
  s_nop 0
  buffer_load_dwordx4 v8, s[64:67], s12 offen nt lds
  s_mov_b32 m0, 0x9000
  s_nop 0
  buffer_load_dwordx4 v8, s[68:71], s12 offen nt lds
  s_add_u32 s12, s12, 28672
  s_mov_b32 m0, 0x7400
  s_nop 0
  buffer_load_dwordx4 v8, s[64:67], s12 offen nt lds
  s_mov_b32 m0, 0x9400
  s_nop 0
  buffer_load_dwordx4 v8, s[68:71], s12 offen nt lds
  s_add_u32 s12, s12, 28672
  s_mov_b32 m0, 0x7800
  s_nop 0
  buffer_load_dwordx4 v8, s[64:67], s12 offen nt lds
  s_mov_b32 m0, 0x9800
  s_nop 0
  buffer_load_dwordx4 v8, s[68:71], s12 offen nt lds
  s_add_u32 s12, s12, 28672
  s_mov_b32 m0, 0x7c00
  s_nop 0
  buffer_load_dwordx4 v8, s[64:67], s12 offen nt lds
  s_mov_b32 m0, 0x9c00
  s_nop 0
  buffer_load_dwordx4 v8, s[68:71], s12 offen nt lds
  buffer_load_dwordx4 v[24:27], v1, s[60:63], 0 offen
  s_mov_b32 m0, 0xa000
  s_nop 0
  buffer_load_dwordx4 v9, s[72:75], s20 offen offset:0 nt lds
  s_mov_b32 m0, 0x9c00
  s_nop 0
  buffer_load_dwordx4 v9, s[72:75], s20 offen offset:2048 nt lds
  s_add_u32 s20, s20, 4096
  s_mov_b32 m0, 0xa800
  s_nop 0
  buffer_load_dwordx4 v9, s[72:75], s20 offen offset:0 nt lds
  s_mov_b32 m0, 0xa400
  s_nop 0
  buffer_load_dwordx4 v9, s[72:75], s20 offen offset:2048 nt lds
  s_add_u32 s20, s20, 4096
  s_mov_b32 m0, 0xb000
  s_nop 0
  buffer_load_dwordx4 v9, s[72:75], s20 offen offset:0 nt lds
  s_mov_b32 m0, 0xac00
  s_nop 0
  buffer_load_dwordx4 v9, s[72:75], s20 offen offset:2048 nt lds
  s_add_u32 s20, s20, 4096
  s_mov_b32 m0, 0xb800
  s_nop 0
  buffer_load_dwordx4 v9, s[72:75], s20 offen offset:0 nt lds
  s_mov_b32 m0, 0xb400
  s_nop 0
  buffer_load_dwordx4 v9, s[72:75], s20 offen offset:2048 nt lds
  s_add_u32 s13, s21, 0
  s_mov_b32 m0, 0xc000
  s_nop 0
  buffer_load_dwordx4 v10, s[76:79], s13 offen nt lds
  s_add_u32 s13, s21, 16384
  s_mov_b32 m0, 0xc400
  s_nop 0
  buffer_load_dwordx4 v10, s[76:79], s13 offen nt lds
  s_add_u32 s13, s21, 1024
  s_mov_b32 m0, 0xc800
  s_nop 0
  buffer_load_dwordx4 v10, s[76:79], s13 offen nt lds
  s_add_u32 s13, s21, 17408
  s_mov_b32 m0, 0xcc00
  s_nop 0
  buffer_load_dwordx4 v10, s[76:79], s13 offen nt lds
  s_add_u32 s13, s21, 2048
  s_mov_b32 m0, 0xd000
  s_nop 0
  buffer_load_dwordx4 v10, s[76:79], s13 offen nt lds
  s_add_u32 s13, s21, 18432
  s_mov_b32 m0, 0xd400
  s_nop 0
  buffer_load_dwordx4 v10, s[76:79], s13 offen nt lds
  s_add_u32 s13, s21, 3072
  s_mov_b32 m0, 0xd800
  s_nop 0
  buffer_load_dwordx4 v10, s[76:79], s13 offen nt lds
  s_add_u32 s13, s21, 19456
  s_mov_b32 m0, 0xdc00
  s_nop 0
  buffer_load_dwordx4 v10, s[76:79], s13 offen nt lds
  s_add_u32 s13, s21, 4096
  s_mov_b32 m0, 0xe000
  s_nop 0
  buffer_load_dwordx4 v10, s[76:79], s13 offen nt lds
  s_add_u32 s13, s21, 20480
  s_mov_b32 m0, 0xe400
  s_nop 0
  buffer_load_dwordx4 v10, s[76:79], s13 offen nt lds
  s_add_u32 s13, s21, 5120
  s_mov_b32 m0, 0xe800
  s_nop 0
  buffer_load_dwordx4 v10, s[76:79], s13 offen nt lds
  s_add_u32 s13, s21, 21504
  s_mov_b32 m0, 0xec00
  s_nop 0
  buffer_load_dwordx4 v10, s[76:79], s13 offen nt lds
  s_add_u32 s13, s21, 6144
  s_mov_b32 m0, 0xf000
  s_nop 0
  buffer_load_dwordx4 v10, s[76:79], s13 offen nt lds
  s_add_u32 s13, s21, 22528
  s_mov_b32 m0, 0xf400
  s_nop 0
  buffer_load_dwordx4 v10, s[76:79], s13 offen nt lds
  s_add_u32 s13, s21, 7168
  s_mov_b32 m0, 0xf800
  s_nop 0
  buffer_load_dwordx4 v10, s[76:79], s13 offen nt lds
  s_add_u32 s13, s21, 23552
  s_mov_b32 m0, 0xfc00
  s_nop 0
  buffer_load_dwordx4 v10, s[76:79], s13 offen nt lds
  s_waitcnt vmcnt(41)
L_qcheck:
  v_mov_b32 v28, 0
  v_mov_b32 v29, 0
  v_msad_u8 v28, v32, s16, v28
  v_msad_u8 v29, v33, s17, v29
  v_msad_u8 v28, v34, s18, v28
  v_msad_u8 v29, v35, s19, v29
  v_msad_u8 v28, v36, s16, v28
  v_msad_u8 v29, v37, s17, v29
  v_msad_u8 v28, v38, s18, v28
  v_msad_u8 v29, v39, s19, v29
  v_msad_u8 v28, v40, s16, v28
  v_msad_u8 v29, v41, s17, v29
  v_msad_u8 v28, v42, s18, v28
  v_msad_u8 v29, v43, s19, v29
  v_msad_u8 v28, v44, s16, v28
  v_msad_u8 v29, v45, s17, v29
  v_msad_u8 v28, v46, s18, v28
  v_msad_u8 v29, v47, s19, v29
  v_msad_u8 v28, v48, s16, v28
  v_msad_u8 v29, v49, s17, v29
  v_msad_u8 v28, v50, s18, v28
  v_msad_u8 v29, v51, s19, v29
  v_msad_u8 v28, v52, s16, v28
  v_msad_u8 v29, v53, s17, v29
  v_msad_u8 v28, v54, s18, v28
  v_msad_u8 v29, v55, s19, v29
  v_msad_u8 v28, v56, s16, v28
  v_msad_u8 v29, v57, s17, v29
  v_msad_u8 v28, v58, s18, v28
  v_msad_u8 v29, v59, s19, v29
  v_msad_u8 v28, v60, s16, v28
  v_msad_u8 v29, v61, s17, v29
  v_msad_u8 v28, v62, s18, v28
  v_msad_u8 v29, v63, s19, v29
  v_or_b32 v4, v28, v29
  v_cmp_ne_u32 vcc, 0, v4
  s_cbranch_vccz L_qok
  s_add_u32 s99, s99, 1
  s_cmp_gt_u32 s99, 20000
  s_cbranch_scc1 L_qok
  s_sleep 1
  buffer_load_dwordx4 v[32:35], v5, s[56:59], s6 offen offset:0 sc1
  buffer_load_dwordx4 v[36:39], v5, s[56:59], s6 offen offset:16 sc1
  buffer_load_dwordx4 v[40:43], v5, s[56:59], s6 offen offset:2048 sc1
  buffer_load_dwordx4 v[44:47], v5, s[56:59], s6 offen offset:2064 sc1
  buffer_load_dwordx4 v[48:51], v5, s[56:59], s7 offen offset:0 sc1
  buffer_load_dwordx4 v[52:55], v5, s[56:59], s7 offen offset:16 sc1
  buffer_load_dwordx4 v[56:59], v5, s[56:59], s7 offen offset:2048 sc1
  buffer_load_dwordx4 v[60:63], v5, s[56:59], s7 offen offset:2064 sc1
  s_waitcnt vmcnt(0)
  s_branch L_qcheck
L_qok:
  v_and_b32 v32, 0xffffff00, v32
  v_and_b32 v33, 0xffffff00, v33
  v_and_b32 v34, 0xffffff00, v34
  v_and_b32 v35, 0xffffff00, v35
  v_and_b32 v36, 0xffffff00, v36
  v_and_b32 v37, 0xffffff00, v37
  v_and_b32 v38, 0xffffff00, v38
  v_and_b32 v39, 0xffffff00, v39
  v_and_b32 v40, 0xffffff00, v40
  v_and_b32 v41, 0xffffff00, v41
  v_and_b32 v42, 0xffffff00, v42
  v_and_b32 v43, 0xffffff00, v43
  v_and_b32 v44, 0xffffff00, v44
  v_and_b32 v45, 0xffffff00, v45
  v_and_b32 v46, 0xffffff00, v46
  v_and_b32 v47, 0xffffff00, v47
  v_and_b32 v48, 0xffffff00, v48
  v_and_b32 v49, 0xffffff00, v49
  v_and_b32 v50, 0xffffff00, v50
  v_and_b32 v51, 0xffffff00, v51
  v_and_b32 v52, 0xffffff00, v52
  v_and_b32 v53, 0xffffff00, v53
  v_and_b32 v54, 0xffffff00, v54
  v_and_b32 v55, 0xffffff00, v55
  v_and_b32 v56, 0xffffff00, v56
  v_and_b32 v57, 0xffffff00, v57
  v_and_b32 v58, 0xffffff00, v58
  v_and_b32 v59, 0xffffff00, v59
  v_and_b32 v60, 0xffffff00, v60
  v_and_b32 v61, 0xffffff00, v61
  v_and_b32 v62, 0xffffff00, v62
  v_and_b32 v63, 0xffffff00, v63
  v_add_f32 v32, v32, v40
  v_add_f32 v48, v48, v56
  v_add_f32 v33, v33, v41
  v_add_f32 v49, v49, v57
  v_add_f32 v34, v34, v42
  v_add_f32 v50, v50, v58
  v_add_f32 v35, v35, v43
  v_add_f32 v51, v51, v59
  v_add_f32 v36, v36, v44
  v_add_f32 v52, v52, v60
  v_add_f32 v37, v37, v45
  v_add_f32 v53, v53, v61
  v_add_f32 v38, v38, v46
  v_add_f32 v54, v54, v62
  v_add_f32 v39, v39, v47
  v_add_f32 v55, v55, v63
  v_add_f32 v32, v32, v48
  v_add_f32 v33, v33, v49
  v_add_f32 v34, v34, v50
  v_add_f32 v35, v35, v51
  v_add_f32 v36, v36, v52
  v_add_f32 v37, v37, v53
  v_add_f32 v38, v38, v54
  v_add_f32 v39, v39, v55
  v_cvt_pk_bf16_f32 v40, v32, v33
  v_cvt_pk_bf16_f32 v41, v34, v35
  v_cvt_pk_bf16_f32 v42, v36, v37
  v_cvt_pk_bf16_f32 v43, v38, v39
  ds_write_b128 v1, v[40:43] offset:18688
  s_waitcnt lgkmcnt(0)
  s_barrier
  s_setprio 3
  s_lshl_b32 s8, s97, 3
  s_add_u32 s8, s8, s4
  s_mul_i32 s8, s8, 7
  s_sub_u32 s9, s98, s4
  s_sub_u32 s9, s9, 1
  s_and_b32 s9, s9, 7
  s_add_u32 s10, s8, s9
  s_lshl_b32 s15, s4, 2
  s_add_u32 s15, s15, s97
  s_bfe_u32 s13, s5, 0x20001
  s_lshl_b32 s14, s15, 2
  s_add_u32 s14, s14, s13
  s_and_b32 s11, s5, 1
  s_cmp_lt_u32 s9, 7
  s_cbranch_scc0 L_nomoe1
  s_lshr_b32 s8, s10, 3
  s_and_b32 s9, s10, 7
  s_waitcnt vmcnt(25)
  ds_read_b128 v[32:35], v1 offset:24576
  ds_read_b128 v[64:67], v1 offset:32768
  ds_read_b128 v[36:39], v1 offset:25600
  ds_read_b128 v[68:71], v1 offset:33792
  ds_read_b128 v[40:43], v1 offset:26624
  ds_read_b128 v[72:75], v1 offset:34816
  ds_read_b128 v[44:47], v1 offset:27648
  ds_read_b128 v[76:79], v1 offset:35840
  ds_read_b128 v[48:51], v1 offset:28672
  ds_read_b128 v[80:83], v1 offset:36864
  ds_read_b128 v[52:55], v1 offset:29696
  ds_read_b128 v[84:87], v1 offset:37888
  ds_read_b128 v[56:59], v1 offset:30720
  ds_read_b128 v[88:91], v1 offset:38912
  ds_read_b128 v[60:63], v1 offset:31744
  ds_read_b128 v[92:95], v1 offset:39936
  v_lshrrev_b32 v4, 3, v0
  v_lshlrev_b32 v4, 2, v4
  s_lshl_b32 s13, s9, 8
  v_add_u32 v4, s13, v4
  ds_read_b32 v96, v4 offset:19712
  ds_read_b32 v97, v4 offset:19744
  ds_read_b32 v98, v4 offset:19776
  ds_read_b32 v99, v4 offset:19808
  ds_read_b32 v100, v4 offset:19840
  ds_read_b32 v101, v4 offset:19872
  ds_read_b32 v102, v4 offset:19904
  ds_read_b32 v103, v4 offset:19936
  v_mov_b32 v104, 0
  v_mov_b32 v105, 0
  v_mov_b32 v106, 0
  v_mov_b32 v107, 0
  v_mov_b32 v108, 0
  v_mov_b32 v109, 0
  v_mov_b32 v110, 0
  v_mov_b32 v111, 0
  v_mov_b32 v112, 0
  v_mov_b32 v113, 0
  v_mov_b32 v114, 0
  v_mov_b32 v115, 0
  v_mov_b32 v116, 0
  v_mov_b32 v117, 0
  v_mov_b32 v118, 0
  v_mov_b32 v119, 0
  s_waitcnt lgkmcnt(0)
  v_lshrrev_b32 v29, 16, v96
  v_dot2c_f32_bf16 v104, v32, v29
  v_dot2c_f32_bf16 v105, v32, v96
  v_dot2c_f32_bf16 v112, v64, v29
  v_dot2c_f32_bf16 v113, v64, v96
  v_dot2c_f32_bf16 v106, v33, v29
  v_dot2c_f32_bf16 v107, v33, v96
  v_dot2c_f32_bf16 v114, v65, v29
  v_dot2c_f32_bf16 v115, v65, v96
  v_dot2c_f32_bf16 v108, v34, v29
  v_dot2c_f32_bf16 v109, v34, v96
  v_dot2c_f32_bf16 v116, v66, v29
  v_dot2c_f32_bf16 v117, v66, v96
  v_dot2c_f32_bf16 v110, v35, v29
  v_dot2c_f32_bf16 v111, v35, v96
  v_dot2c_f32_bf16 v118, v67, v29
  v_dot2c_f32_bf16 v119, v67, v96
  v_lshrrev_b32 v29, 16, v97
  v_dot2c_f32_bf16 v104, v36, v29
  v_dot2c_f32_bf16 v105, v36, v97
  v_dot2c_f32_bf16 v112, v68, v29
  v_dot2c_f32_bf16 v113, v68, v97
  v_dot2c_f32_bf16 v106, v37, v29
  v_dot2c_f32_bf16 v107, v37, v97
  v_dot2c_f32_bf16 v114, v69, v29
  v_dot2c_f32_bf16 v115, v69, v97
  v_dot2c_f32_bf16 v108, v38, v29
  v_dot2c_f32_bf16 v109, v38, v97
  v_dot2c_f32_bf16 v116, v70, v29
  v_dot2c_f32_bf16 v117, v70, v97
  v_dot2c_f32_bf16 v110, v39, v29
  v_dot2c_f32_bf16 v111, v39, v97
  v_dot2c_f32_bf16 v118, v71, v29
  v_dot2c_f32_bf16 v119, v71, v97
  v_lshrrev_b32 v29, 16, v98
  v_dot2c_f32_bf16 v104, v40, v29
  v_dot2c_f32_bf16 v105, v40, v98
  v_dot2c_f32_bf16 v112, v72, v29
  v_dot2c_f32_bf16 v113, v72, v98
  v_dot2c_f32_bf16 v106, v41, v29
  v_dot2c_f32_bf16 v107, v41, v98
  v_dot2c_f32_bf16 v114, v73, v29
  v_dot2c_f32_bf16 v115, v73, v98
  v_dot2c_f32_bf16 v108, v42, v29
  v_dot2c_f32_bf16 v109, v42, v98
  v_dot2c_f32_bf16 v116, v74, v29
  v_dot2c_f32_bf16 v117, v74, v98
  v_dot2c_f32_bf16 v110, v43, v29
  v_dot2c_f32_bf16 v111, v43, v98
  v_dot2c_f32_bf16 v118, v75, v29
  v_dot2c_f32_bf16 v119, v75, v98
  v_lshrrev_b32 v29, 16, v99
  v_dot2c_f32_bf16 v104, v44, v29
  v_dot2c_f32_bf16 v105, v44, v99
  v_dot2c_f32_bf16 v112, v76, v29
  v_dot2c_f32_bf16 v113, v76, v99
  v_dot2c_f32_bf16 v106, v45, v29
  v_dot2c_f32_bf16 v107, v45, v99
  v_dot2c_f32_bf16 v114, v77, v29
  v_dot2c_f32_bf16 v115, v77, v99
  v_dot2c_f32_bf16 v108, v46, v29
  v_dot2c_f32_bf16 v109, v46, v99
  v_dot2c_f32_bf16 v116, v78, v29
  v_dot2c_f32_bf16 v117, v78, v99
  v_dot2c_f32_bf16 v110, v47, v29
  v_dot2c_f32_bf16 v111, v47, v99
  v_dot2c_f32_bf16 v118, v79, v29
  v_dot2c_f32_bf16 v119, v79, v99
  v_lshrrev_b32 v29, 16, v100
  v_dot2c_f32_bf16 v104, v48, v29
  v_dot2c_f32_bf16 v105, v48, v100
  v_dot2c_f32_bf16 v112, v80, v29
  v_dot2c_f32_bf16 v113, v80, v100
  v_dot2c_f32_bf16 v106, v49, v29
  v_dot2c_f32_bf16 v107, v49, v100
  v_dot2c_f32_bf16 v114, v81, v29
  v_dot2c_f32_bf16 v115, v81, v100
  v_dot2c_f32_bf16 v108, v50, v29
  v_dot2c_f32_bf16 v109, v50, v100
  v_dot2c_f32_bf16 v116, v82, v29
  v_dot2c_f32_bf16 v117, v82, v100
  v_dot2c_f32_bf16 v110, v51, v29
  v_dot2c_f32_bf16 v111, v51, v100
  v_dot2c_f32_bf16 v118, v83, v29
  v_dot2c_f32_bf16 v119, v83, v100
  v_lshrrev_b32 v29, 16, v101
  v_dot2c_f32_bf16 v104, v52, v29
  v_dot2c_f32_bf16 v105, v52, v101
  v_dot2c_f32_bf16 v112, v84, v29
  v_dot2c_f32_bf16 v113, v84, v101
  v_dot2c_f32_bf16 v106, v53, v29
  v_dot2c_f32_bf16 v107, v53, v101
  v_dot2c_f32_bf16 v114, v85, v29
  v_dot2c_f32_bf16 v115, v85, v101
  v_dot2c_f32_bf16 v108, v54, v29
  v_dot2c_f32_bf16 v109, v54, v101
  v_dot2c_f32_bf16 v116, v86, v29
  v_dot2c_f32_bf16 v117, v86, v101
  v_dot2c_f32_bf16 v110, v55, v29
  v_dot2c_f32_bf16 v111, v55, v101
  v_dot2c_f32_bf16 v118, v87, v29
  v_dot2c_f32_bf16 v119, v87, v101
  v_lshrrev_b32 v29, 16, v102
  v_dot2c_f32_bf16 v104, v56, v29
  v_dot2c_f32_bf16 v105, v56, v102
  v_dot2c_f32_bf16 v112, v88, v29
  v_dot2c_f32_bf16 v113, v88, v102
  v_dot2c_f32_bf16 v106, v57, v29
  v_dot2c_f32_bf16 v107, v57, v102
  v_dot2c_f32_bf16 v114, v89, v29
  v_dot2c_f32_bf16 v115, v89, v102
  v_dot2c_f32_bf16 v108, v58, v29
  v_dot2c_f32_bf16 v109, v58, v102
  v_dot2c_f32_bf16 v116, v90, v29
  v_dot2c_f32_bf16 v117, v90, v102
  v_dot2c_f32_bf16 v110, v59, v29
  v_dot2c_f32_bf16 v111, v59, v102
  v_dot2c_f32_bf16 v118, v91, v29
  v_dot2c_f32_bf16 v119, v91, v102
  v_lshrrev_b32 v29, 16, v103
  v_dot2c_f32_bf16 v104, v60, v29
  v_dot2c_f32_bf16 v105, v60, v103
  v_dot2c_f32_bf16 v112, v92, v29
  v_dot2c_f32_bf16 v113, v92, v103
  v_dot2c_f32_bf16 v106, v61, v29
  v_dot2c_f32_bf16 v107, v61, v103
  v_dot2c_f32_bf16 v114, v93, v29
  v_dot2c_f32_bf16 v115, v93, v103
  v_dot2c_f32_bf16 v108, v62, v29
  v_dot2c_f32_bf16 v109, v62, v103
  v_dot2c_f32_bf16 v116, v94, v29
  v_dot2c_f32_bf16 v117, v94, v103
  v_dot2c_f32_bf16 v110, v63, v29
  v_dot2c_f32_bf16 v111, v63, v103
  v_dot2c_f32_bf16 v118, v95, v29
  v_dot2c_f32_bf16 v119, v95, v103
  v_add_f32_dpp v104, v104, v104 row_ror:8 row_mask:0xf bank_mask:0xf
  v_add_f32_dpp v105, v105, v105 row_ror:8 row_mask:0xf bank_mask:0xf
  v_add_f32_dpp v106, v106, v106 row_ror:8 row_mask:0xf bank_mask:0xf
  v_add_f32_dpp v107, v107, v107 row_ror:8 row_mask:0xf bank_mask:0xf
  v_add_f32_dpp v108, v108, v108 row_ror:8 row_mask:0xf bank_mask:0xf
  v_add_f32_dpp v109, v109, v109 row_ror:8 row_mask:0xf bank_mask:0xf
  v_add_f32_dpp v110, v110, v110 row_ror:8 row_mask:0xf bank_mask:0xf
  v_add_f32_dpp v111, v111, v111 row_ror:8 row_mask:0xf bank_mask:0xf
  v_add_f32_dpp v112, v112, v112 row_ror:8 row_mask:0xf bank_mask:0xf
  v_add_f32_dpp v113, v113, v113 row_ror:8 row_mask:0xf bank_mask:0xf
  v_add_f32_dpp v114, v114, v114 row_ror:8 row_mask:0xf bank_mask:0xf
  v_add_f32_dpp v115, v115, v115 row_ror:8 row_mask:0xf bank_mask:0xf
  v_add_f32_dpp v116, v116, v116 row_ror:8 row_mask:0xf bank_mask:0xf
  v_add_f32_dpp v117, v117, v117 row_ror:8 row_mask:0xf bank_mask:0xf
  v_add_f32_dpp v118, v118, v118 row_ror:8 row_mask:0xf bank_mask:0xf
  v_add_f32_dpp v119, v119, v119 row_ror:8 row_mask:0xf bank_mask:0xf
  v_mov_b32 v32, v104
  v_mov_b32 v33, v105
  v_mov_b32 v34, v106
  v_mov_b32 v35, v107
  v_mov_b32 v36, v108
  v_mov_b32 v37, v109
  v_mov_b32 v38, v110
  v_mov_b32 v39, v111
  v_mov_b32 v40, v112
  v_mov_b32 v41, v113
  v_mov_b32 v42, v114
  v_mov_b32 v43, v115
  v_mov_b32 v44, v116
  v_mov_b32 v45, v117
  v_mov_b32 v46, v118
  v_mov_b32 v47, v119
  v_permlane16_swap_b32 v32, v104
  v_permlane16_swap_b32 v33, v105
  v_permlane16_swap_b32 v34, v106
  v_permlane16_swap_b32 v35, v107
  v_permlane16_swap_b32 v36, v108
  v_permlane16_swap_b32 v37, v109
  v_permlane16_swap_b32 v38, v110
  v_permlane16_swap_b32 v39, v111
  v_permlane16_swap_b32 v40, v112
  v_permlane16_swap_b32 v41, v113
  v_permlane16_swap_b32 v42, v114
  v_permlane16_swap_b32 v43, v115
  v_permlane16_swap_b32 v44, v116
  v_permlane16_swap_b32 v45, v117
  v_permlane16_swap_b32 v46, v118
  v_permlane16_swap_b32 v47, v119
  v_add_f32 v104, v104, v32
  v_add_f32 v105, v105, v33
  v_add_f32 v106, v106, v34
  v_add_f32 v107, v107, v35
  v_add_f32 v108, v108, v36
  v_add_f32 v109, v109, v37
  v_add_f32 v110, v110, v38
  v_add_f32 v111, v111, v39
  v_add_f32 v112, v112, v40
  v_add_f32 v113, v113, v41
  v_add_f32 v114, v114, v42
  v_add_f32 v115, v115, v43
  v_add_f32 v116, v116, v44
  v_add_f32 v117, v117, v45
  v_add_f32 v118, v118, v46
  v_add_f32 v119, v119, v47
  v_mov_b32 v32, v104
  v_mov_b32 v33, v105
  v_mov_b32 v34, v106
  v_mov_b32 v35, v107
  v_mov_b32 v36, v108
  v_mov_b32 v37, v109
  v_mov_b32 v38, v110
  v_mov_b32 v39, v111
  v_mov_b32 v40, v112
  v_mov_b32 v41, v113
  v_mov_b32 v42, v114
  v_mov_b32 v43, v115
  v_mov_b32 v44, v116
  v_mov_b32 v45, v117
  v_mov_b32 v46, v118
  v_mov_b32 v47, v119
  v_permlane32_swap_b32 v32, v104
  v_permlane32_swap_b32 v33, v105
  v_permlane32_swap_b32 v34, v106
  v_permlane32_swap_b32 v35, v107
  v_permlane32_swap_b32 v36, v108
  v_permlane32_swap_b32 v37, v109
  v_permlane32_swap_b32 v38, v110
  v_permlane32_swap_b32 v39, v111
  v_permlane32_swap_b32 v40, v112
  v_permlane32_swap_b32 v41, v113
  v_permlane32_swap_b32 v42, v114
  v_permlane32_swap_b32 v43, v115
  v_permlane32_swap_b32 v44, v116
  v_permlane32_swap_b32 v45, v117
  v_permlane32_swap_b32 v46, v118
  v_permlane32_swap_b32 v47, v119
  v_add_f32 v104, v104, v32
  v_add_f32 v105, v105, v33
  v_add_f32 v106, v106, v34
  v_add_f32 v107, v107, v35
  v_add_f32 v108, v108, v36
  v_add_f32 v109, v109, v37
  v_add_f32 v110, v110, v38
  v_add_f32 v111, v111, v39
  v_add_f32 v112, v112, v40
  v_add_f32 v113, v113, v41
  v_add_f32 v114, v114, v42
  v_add_f32 v115, v115, v43
  v_add_f32 v116, v116, v44
  v_add_f32 v117, v117, v45
  v_add_f32 v118, v118, v46
  v_add_f32 v119, v119, v47
  v_bfe_u32 v4, v0, 3, 2
  v_cmp_eq_u32 vcc, 1, v4
  s_nop 1
  v_cndmask_b32 v48, v104, v108, vcc
  v_cndmask_b32 v49, v105, v109, vcc
  v_cndmask_b32 v50, v106, v110, vcc
  v_cndmask_b32 v51, v107, v111, vcc
  v_cmp_eq_u32 vcc, 2, v4
  s_nop 1
  v_cndmask_b32 v48, v48, v112, vcc
  v_cndmask_b32 v49, v49, v113, vcc
  v_cndmask_b32 v50, v50, v114, vcc
  v_cndmask_b32 v51, v51, v115, vcc
  v_cmp_eq_u32 vcc, 3, v4
  s_nop 1
  v_cndmask_b32 v48, v48, v116, vcc
  v_cndmask_b32 v49, v49, v117, vcc
  v_cndmask_b32 v50, v50, v118, vcc
  v_cndmask_b32 v51, v51, v119, vcc
  v_and_b32 v48, 0xffffff00, v48
  v_and_b32 v49, 0xffffff00, v49
  v_and_b32 v50, 0xffffff00, v50
  v_and_b32 v51, 0xffffff00, v51
  v_or_b32 v48, s16, v48
  v_or_b32 v49, s17, v49
  v_or_b32 v50, s18, v50
  v_or_b32 v51, s19, v51
  v_bfe_u32 v5, v0, 1, 2
  v_lshlrev_b32 v5, 10, v5
  v_and_b32 v7, 1, v0
  v_lshl_add_u32 v5, v7, 5, v5
  v_lshrrev_b32 v7, 1, v4
  v_lshl_add_u32 v5, v7, 6, v5
  v_and_b32 v7, 1, v4
  v_lshl_add_u32 v5, v7, 4, v5
  s_lshl_b32 s12, s8, 12
  s_lshl_b32 s13, s9, 7
  s_add_u32 s12, s12, s13
  s_add_u32 s12, s12, 0x20000
  s_mov_b64 exec, 0xffffffff
  buffer_store_dwordx4 v[48:51], v5, s[56:59], s12 offen sc1
  s_mov_b64 exec, -1
L_nomoe1:
  s_waitcnt vmcnt(24)
  v_lshlrev_b32 v8, 16, v24
  v_and_b32 v9, 0xffff0000, v24
  v_lshlrev_b32 v10, 16, v25
  v_and_b32 v11, 0xffff0000, v25
  v_lshlrev_b32 v12, 16, v26
  v_and_b32 v13, 0xffff0000, v26
  v_lshlrev_b32 v14, 16, v27
  v_and_b32 v15, 0xffff0000, v27
  v_mul_f32 v4, v8, v16
  v_fmac_f32 v4, v9, v17
  v_fmac_f32 v4, v10, v18
  v_fmac_f32 v4, v11, v19
  v_fmac_f32 v4, v12, v20
  v_fmac_f32 v4, v13, v21
  v_fmac_f32 v4, v14, v22
  v_fmac_f32 v4, v15, v23
  s_nop 1
  v_add_f32_dpp v4, v4, v4 row_ror:1 row_mask:0xf bank_mask:0xf
  s_nop 1
  v_add_f32_dpp v4, v4, v4 row_ror:2 row_mask:0xf bank_mask:0xf
  s_nop 1
  v_add_f32_dpp v4, v4, v4 row_ror:4 row_mask:0xf bank_mask:0xf
  s_nop 1
  v_add_f32_dpp v4, v4, v4 row_ror:8 row_mask:0xf bank_mask:0xf
  v_mov_b32 v7, v4
  s_nop 1
  v_permlane16_swap_b32 v7, v4
  v_add_f32 v4, v4, v7
  v_mov_b32 v7, v4
  s_nop 1
  v_permlane32_swap_b32 v7, v4
  v_add_f32 v4, v4, v7
  v_cvt_pk_bf16_f32 v7, v4, v4
  v_lshlrev_b32 v4, 16, v7
  v_mul_f32 v4, s43, v4
  v_sub_f32 v4, 0, v4
  v_exp_f32 v4, v4
  s_nop 0
  v_add_f32 v4, 1.0, v4
  v_rcp_f32 v4, v4
  s_nop 0
  v_cvt_pk_bf16_f32 v7, v4, v4
  v_lshlrev_b32 v4, 16, v7
  v_mov_b32 v28, v4
  v_mov_b32 v8, 0
  v_mov_b32 v9, 0
  v_mov_b32 v10, 0
  v_mov_b32 v11, 0
  s_cmp_lt_u32 s14, 112
  s_cbranch_scc0 L_nomoe2
  s_lshl_b32 s12, s14, 10
  s_add_u32 s12, s12, 0x20000
L_mpoll:
  buffer_load_dwordx4 v[24:27], v1, s[56:59], s12 offen sc1
  s_waitcnt vmcnt(0)
  v_mov_b32 v4, 0
  v_msad_u8 v4, v24, s16, v4
  v_msad_u8 v4, v25, s17, v4
  v_msad_u8 v4, v26, s18, v4
  v_msad_u8 v4, v27, s19, v4
  v_cmp_ne_u32 vcc, 0, v4
  s_cbranch_vccz L_mok
  s_add_u32 s99, s99, 1
  s_cmp_gt_u32 s99, 20000
  s_cbranch_scc1 L_mok
  s_sleep 8
  s_branch L_mpoll
L_mok:
  ds_read_b128 v[128:131], v1 offset:40960
  ds_read_b128 v[132:135], v1 offset:41984
  ds_read_b128 v[136:139], v1 offset:43008
  ds_read_b128 v[140:143], v1 offset:44032
  ds_read_b128 v[144:147], v1 offset:45056
  ds_read_b128 v[148:151], v1 offset:46080
  ds_read_b128 v[152:155], v1 offset:47104
  ds_read_b128 v[156:159], v1 offset:48128
  v_and_b32 v24, 0xffffff00, v24
  v_and_b32 v25, 0xffffff00, v25
  v_and_b32 v26, 0xffffff00, v26
  v_and_b32 v27, 0xffffff00, v27
  v_add_f32_dpp v24, v24, v24 row_ror:8 row_mask:0xf bank_mask:0xf
  v_add_f32_dpp v25, v25, v25 row_ror:8 row_mask:0xf bank_mask:0xf
  v_add_f32_dpp v26, v26, v26 row_ror:8 row_mask:0xf bank_mask:0xf
  v_add_f32_dpp v27, v27, v27 row_ror:8 row_mask:0xf bank_mask:0xf
  v_mov_b32 v96, v24
  v_mov_b32 v97, v25
  v_mov_b32 v98, v26
  v_mov_b32 v99, v27
  v_permlane16_swap_b32 v96, v24
  v_permlane16_swap_b32 v97, v25
  v_permlane16_swap_b32 v98, v26
  v_permlane16_swap_b32 v99, v27
  v_add_f32 v24, v24, v96
  v_add_f32 v25, v25, v97
  v_add_f32 v26, v26, v98
  v_add_f32 v27, v27, v99
  v_mov_b32 v96, v24
  v_mov_b32 v97, v25
  v_mov_b32 v98, v26
  v_mov_b32 v99, v27
  v_permlane32_swap_b32 v96, v24
  v_permlane32_swap_b32 v97, v25
  v_permlane32_swap_b32 v98, v26
  v_permlane32_swap_b32 v99, v27
  v_add_f32 v24, v24, v96
  v_add_f32 v25, v25, v97
  v_add_f32 v26, v26, v98
  v_add_f32 v27, v27, v99
  v_mov_b32_dpp v12, v24 row_ror:4 row_mask:0xf bank_mask:0xf
  v_mov_b32_dpp v13, v25 row_ror:4 row_mask:0xf bank_mask:0xf
  v_mov_b32_dpp v14, v26 row_ror:4 row_mask:0xf bank_mask:0xf
  v_mov_b32_dpp v15, v27 row_ror:4 row_mask:0xf bank_mask:0xf
  v_cvt_pk_bf16_f32 v20, v24, v25
  v_cvt_pk_bf16_f32 v21, v26, v27
  v_lshlrev_b32 v24, 16, v20
  v_and_b32 v25, 0xffff0000, v20
  v_lshlrev_b32 v26, 16, v21
  v_and_b32 v27, 0xffff0000, v21
  v_cvt_pk_bf16_f32 v20, v12, v13
  v_cvt_pk_bf16_f32 v21, v14, v15
  v_lshlrev_b32 v12, 16, v20
  v_and_b32 v13, 0xffff0000, v20
  v_lshlrev_b32 v14, 16, v21
  v_and_b32 v15, 0xffff0000, v21
  v_mul_f32 v16, s43, v24
  v_mul_f32 v17, s43, v25
  v_mul_f32 v18, s43, v26
  v_mul_f32 v19, s43, v27
  v_sub_f32 v16, 0, v16
  v_sub_f32 v17, 0, v17
  v_sub_f32 v18, 0, v18
  v_sub_f32 v19, 0, v19
  v_exp_f32 v16, v16
  v_exp_f32 v17, v17
  v_exp_f32 v18, v18
  v_exp_f32 v19, v19
  v_add_f32 v16, 1.0, v16
  v_add_f32 v17, 1.0, v17
  v_add_f32 v18, 1.0, v18
  v_add_f32 v19, 1.0, v19
  v_rcp_f32 v16, v16
  v_rcp_f32 v17, v17
  v_rcp_f32 v18, v18
  v_rcp_f32 v19, v19
  v_mul_f32 v24, v24, v16
  v_mul_f32 v25, v25, v17
  v_mul_f32 v26, v26, v18
  v_mul_f32 v27, v27, v19
  v_cvt_pk_bf16_f32 v20, v24, v25
  v_cvt_pk_bf16_f32 v21, v26, v27
  v_lshlrev_b32 v24, 16, v20
  v_and_b32 v25, 0xffff0000, v20
  v_lshlrev_b32 v26, 16, v21
  v_and_b32 v27, 0xffff0000, v21
  v_mul_f32 v24, v24, v12
  v_mul_f32 v25, v25, v13
  v_mul_f32 v26, v26, v14
  v_mul_f32 v27, v27, v15
  v_cvt_pk_bf16_f32 v20, v24, v25
  v_cvt_pk_bf16_f32 v21, v26, v27
  v_readlane_b32 s60, v20, 0
  v_readlane_b32 s61, v21, 0
  v_readlane_b32 s62, v20, 1
  v_readlane_b32 s63, v21, 1
  v_readlane_b32 s64, v20, 2
  v_readlane_b32 s65, v21, 2
  v_readlane_b32 s66, v20, 3
  v_readlane_b32 s67, v21, 3
  s_waitcnt lgkmcnt(0)
  v_permlane32_swap_b32 v128, v130
  v_permlane32_swap_b32 v129, v131
  v_permlane32_swap_b32 v132, v134
  v_permlane32_swap_b32 v133, v135
  v_permlane32_swap_b32 v136, v138
  v_permlane32_swap_b32 v137, v139
  v_permlane32_swap_b32 v140, v142
  v_permlane32_swap_b32 v141, v143
  v_permlane32_swap_b32 v144, v146
  v_permlane32_swap_b32 v145, v147
  v_permlane32_swap_b32 v148, v150
  v_permlane32_swap_b32 v149, v151
  v_permlane32_swap_b32 v152, v154
  v_permlane32_swap_b32 v153, v155
  v_permlane32_swap_b32 v156, v158
  v_permlane32_swap_b32 v157, v159
  v_perm_b32 v96, v130, v128, s44
  v_perm_b32 v97, v130, v128, s45
  v_perm_b32 v98, v131, v129, s44
  v_perm_b32 v99, v131, v129, s45
  v_perm_b32 v100, v134, v132, s44
  v_perm_b32 v101, v134, v132, s45
  v_perm_b32 v102, v135, v133, s44
  v_perm_b32 v103, v135, v133, s45
  v_perm_b32 v104, v138, v136, s44
  v_perm_b32 v105, v138, v136, s45
  v_perm_b32 v106, v139, v137, s44
  v_perm_b32 v107, v139, v137, s45
  v_perm_b32 v108, v142, v140, s44
  v_perm_b32 v109, v142, v140, s45
  v_perm_b32 v110, v143, v141, s44
  v_perm_b32 v111, v143, v141, s45
  v_perm_b32 v112, v146, v144, s44
  v_perm_b32 v113, v146, v144, s45
  v_perm_b32 v114, v147, v145, s44
  v_perm_b32 v115, v147, v145, s45
  v_perm_b32 v116, v150, v148, s44
  v_perm_b32 v117, v150, v148, s45
  v_perm_b32 v118, v151, v149, s44
  v_perm_b32 v119, v151, v149, s45
  v_perm_b32 v120, v154, v152, s44
  v_perm_b32 v121, v154, v152, s45
  v_perm_b32 v122, v155, v153, s44
  v_perm_b32 v123, v155, v153, s45
  v_perm_b32 v124, v158, v156, s44
  v_perm_b32 v125, v158, v156, s45
  v_perm_b32 v126, v159, v157, s44
  v_perm_b32 v127, v159, v157, s45
  v_dot2c_f32_bf16 v8, s60, v96
  v_dot2c_f32_bf16 v9, s60, v97
  v_dot2c_f32_bf16 v10, s60, v98
  v_dot2c_f32_bf16 v11, s60, v99
  v_dot2c_f32_bf16 v8, s61, v100
  v_dot2c_f32_bf16 v9, s61, v101
  v_dot2c_f32_bf16 v10, s61, v102
  v_dot2c_f32_bf16 v11, s61, v103
  v_dot2c_f32_bf16 v8, s62, v104
  v_dot2c_f32_bf16 v9, s62, v105
  v_dot2c_f32_bf16 v10, s62, v106
  v_dot2c_f32_bf16 v11, s62, v107
  v_dot2c_f32_bf16 v8, s63, v108
  v_dot2c_f32_bf16 v9, s63, v109
  v_dot2c_f32_bf16 v10, s63, v110
  v_dot2c_f32_bf16 v11, s63, v111
  v_dot2c_f32_bf16 v8, s64, v112
  v_dot2c_f32_bf16 v9, s64, v113
  v_dot2c_f32_bf16 v10, s64, v114
  v_dot2c_f32_bf16 v11, s64, v115
  v_dot2c_f32_bf16 v8, s65, v116
  v_dot2c_f32_bf16 v9, s65, v117
  v_dot2c_f32_bf16 v10, s65, v118
  v_dot2c_f32_bf16 v11, s65, v119
  v_dot2c_f32_bf16 v8, s66, v120
  v_dot2c_f32_bf16 v9, s66, v121
  v_dot2c_f32_bf16 v10, s66, v122
  v_dot2c_f32_bf16 v11, s66, v123
  v_dot2c_f32_bf16 v8, s67, v124
  v_dot2c_f32_bf16 v9, s67, v125
  v_dot2c_f32_bf16 v10, s67, v126
  v_dot2c_f32_bf16 v11, s67, v127
  v_mul_f32 v8, v8, v28
  v_mul_f32 v9, v9, v28
  v_mul_f32 v10, v10, v28
  v_mul_f32 v11, v11, v28
L_nomoe2:
  s_waitcnt vmcnt(0)
  ds_read_b128 v[32:35], v1 offset:49152
  ds_read_b128 v[36:39], v1 offset:50176
  ds_read_b128 v[40:43], v1 offset:51200
  ds_read_b128 v[44:47], v1 offset:52224
  ds_read_b128 v[48:51], v1 offset:53248
  ds_read_b128 v[52:55], v1 offset:54272
  ds_read_b128 v[56:59], v1 offset:55296
  ds_read_b128 v[60:63], v1 offset:56320
  ds_read_b128 v[64:67], v1 offset:57344
  ds_read_b128 v[68:71], v1 offset:58368
  ds_read_b128 v[72:75], v1 offset:59392
  ds_read_b128 v[76:79], v1 offset:60416
  ds_read_b128 v[80:83], v1 offset:61440
  ds_read_b128 v[84:87], v1 offset:62464
  ds_read_b128 v[88:91], v1 offset:63488
  ds_read_b128 v[92:95], v1 offset:64512
  s_waitcnt lgkmcnt(0)
  v_permlane32_swap_b32 v32, v34
  v_permlane32_swap_b32 v33, v35
  v_permlane32_swap_b32 v36, v38
  v_permlane32_swap_b32 v37, v39
  v_permlane32_swap_b32 v40, v42
  v_permlane32_swap_b32 v41, v43
  v_permlane32_swap_b32 v44, v46
  v_permlane32_swap_b32 v45, v47
  v_permlane32_swap_b32 v48, v50
  v_permlane32_swap_b32 v49, v51
  v_permlane32_swap_b32 v52, v54
  v_permlane32_swap_b32 v53, v55
  v_permlane32_swap_b32 v56, v58
  v_permlane32_swap_b32 v57, v59
  v_permlane32_swap_b32 v60, v62
  v_permlane32_swap_b32 v61, v63
  v_permlane32_swap_b32 v64, v66
  v_permlane32_swap_b32 v65, v67
  v_permlane32_swap_b32 v68, v70
  v_permlane32_swap_b32 v69, v71
  v_permlane32_swap_b32 v72, v74
  v_permlane32_swap_b32 v73, v75
  v_permlane32_swap_b32 v76, v78
  v_permlane32_swap_b32 v77, v79
  v_permlane32_swap_b32 v80, v82
  v_permlane32_swap_b32 v81, v83
  v_permlane32_swap_b32 v84, v86
  v_permlane32_swap_b32 v85, v87
  v_permlane32_swap_b32 v88, v90
  v_permlane32_swap_b32 v89, v91
  v_permlane32_swap_b32 v92, v94
  v_permlane32_swap_b32 v93, v95
  v_perm_b32 v96, v34, v32, s44
  v_perm_b32 v97, v34, v32, s45
  v_perm_b32 v98, v35, v33, s44
  v_perm_b32 v99, v35, v33, s45
  v_perm_b32 v100, v38, v36, s44
  v_perm_b32 v101, v38, v36, s45
  v_perm_b32 v102, v39, v37, s44
  v_perm_b32 v103, v39, v37, s45
  v_perm_b32 v104, v42, v40, s44
  v_perm_b32 v105, v42, v40, s45
  v_perm_b32 v106, v43, v41, s44
  v_perm_b32 v107, v43, v41, s45
  v_perm_b32 v108, v46, v44, s44
  v_perm_b32 v109, v46, v44, s45
  v_perm_b32 v110, v47, v45, s44
  v_perm_b32 v111, v47, v45, s45
  v_perm_b32 v112, v50, v48, s44
  v_perm_b32 v113, v50, v48, s45
  v_perm_b32 v114, v51, v49, s44
  v_perm_b32 v115, v51, v49, s45
  v_perm_b32 v116, v54, v52, s44
  v_perm_b32 v117, v54, v52, s45
  v_perm_b32 v118, v55, v53, s44
  v_perm_b32 v119, v55, v53, s45
  v_perm_b32 v120, v58, v56, s44
  v_perm_b32 v121, v58, v56, s45
  v_perm_b32 v122, v59, v57, s44
  v_perm_b32 v123, v59, v57, s45
  v_perm_b32 v124, v62, v60, s44
  v_perm_b32 v125, v62, v60, s45
  v_perm_b32 v126, v63, v61, s44
  v_perm_b32 v127, v63, v61, s45
  v_perm_b32 v128, v66, v64, s44
  v_perm_b32 v129, v66, v64, s45
  v_perm_b32 v130, v67, v65, s44
  v_perm_b32 v131, v67, v65, s45
  v_perm_b32 v132, v70, v68, s44
  v_perm_b32 v133, v70, v68, s45
  v_perm_b32 v134, v71, v69, s44
  v_perm_b32 v135, v71, v69, s45
  v_perm_b32 v136, v74, v72, s44
  v_perm_b32 v137, v74, v72, s45
  v_perm_b32 v138, v75, v73, s44
  v_perm_b32 v139, v75, v73, s45
  v_perm_b32 v140, v78, v76, s44
  v_perm_b32 v141, v78, v76, s45
  v_perm_b32 v142, v79, v77, s44
  v_perm_b32 v143, v79, v77, s45
  v_perm_b32 v144, v82, v80, s44
  v_perm_b32 v145, v82, v80, s45
  v_perm_b32 v146, v83, v81, s44
  v_perm_b32 v147, v83, v81, s45
  v_perm_b32 v148, v86, v84, s44
  v_perm_b32 v149, v86, v84, s45
  v_perm_b32 v150, v87, v85, s44
  v_perm_b32 v151, v87, v85, s45
  v_perm_b32 v152, v90, v88, s44
  v_perm_b32 v153, v90, v88, s45
  v_perm_b32 v154, v91, v89, s44
  v_perm_b32 v155, v91, v89, s45
  v_perm_b32 v156, v94, v92, s44
  v_perm_b32 v157, v94, v92, s45
  v_perm_b32 v158, v95, v93, s44
  v_perm_b32 v159, v95, v93, s45
  v_lshrrev_b32 v4, 3, v0
  v_lshlrev_b32 v5, 14, v4
  v_and_b32 v6, 7, v0
  v_lshl_add_u32 v5, v6, 4, v5
  v_lshlrev_b32 v6, 4, v4
  v_and_b32 v7, 31, v0
  v_lshlrev_b32 v7, 4, v7
  s_lshl_b32 s12, s4, 11
  s_and_b32 s13, s14, 15
  s_lshl_b32 s13, s13, 7
  s_add_u32 s12, s12, s13
  s_add_u32 s64, s12, 0x100000
  s_add_u32 s65, s64, 0x20000
  s_add_u32 s66, s64, 0x40000
  s_add_u32 s67, s64, 0x60000
  s_lshl_b32 s15, s15, 9
  s_add_u32 s15, s15, 0x200000
  s_lshl_b32 s12, s11, 17
  s_lshl_b32 s13, s14, 10
  s_add_u32 s12, s12, s13
  s_add_u32 s12, s12, 0x300000
  s_lshr_b32 s13, s14, 6
  s_lshl_b32 s13, s13, 17
  s_and_b32 s9, s14, 63
  s_lshl_b32 s9, s9, 4
  s_add_u32 s13, s13, s9
  s_add_u32 s13, s13, 0x300000
  s_add_u32 s10, s13, 0x10000
  v_lshlrev_b32 v2, 10, v0
  s_lshr_b32 s9, s14, 6
  s_lshl_b32 s9, s9, 8
  s_and_b32 s8, s14, 31
  s_lshl_b32 s8, s8, 3
  s_add_u32 s9, s9, s8
  s_bfe_u32 s8, s14, 0x10005
  s_lshl_b32 s8, s8, 2
  s_add_u32 s9, s9, s8
  s_lshl_b32 s14, s9, 1
  s_lshl_b32 s9, s9, 2
  v_mov_b32 v4, s9
  ds_read_b128 v[12:15], v4 offset:21760
  s_waitcnt lgkmcnt(0)
  s_setprio 3
  s_barrier
  s_sleep 30
  s_mov_b64 s[68:69], -1
  s_mov_b64 s[70:71], -1
  s_mov_b64 s[72:73], -1
  s_mov_b64 s[74:75], -1
  s_mov_b64 exec, s[68:69]
  buffer_load_dwordx4 v[48:51], v6, s[56:59], s15 offen offset:0 sc1
  buffer_load_dwordx4 v[32:35], v5, s[56:59], s64 offen sc1
  s_mov_b64 exec, s[70:71]
  buffer_load_dwordx4 v[52:55], v6, s[56:59], s15 offen offset:128 sc1
  buffer_load_dwordx4 v[36:39], v5, s[56:59], s65 offen sc1
  s_mov_b64 exec, s[72:73]
  buffer_load_dwordx4 v[56:59], v6, s[56:59], s15 offen offset:256 sc1
  buffer_load_dwordx4 v[40:43], v5, s[56:59], s66 offen sc1
  s_mov_b64 exec, s[74:75]
  buffer_load_dwordx4 v[60:63], v6, s[56:59], s15 offen offset:384 sc1
  buffer_load_dwordx4 v[44:47], v5, s[56:59], s67 offen sc1
  s_mov_b64 exec, -1
  s_waitcnt vmcnt(0)
  v_xor_b32 v68, s42, v50
  v_xor_b32 v69, s42, v54
  v_xor_b32 v70, s42, v58
  v_xor_b32 v71, s42, v62
  v_msad_u8 v64, v32, s16, 0
  v_msad_u8 v65, v36, s16, 0
  v_msad_u8 v66, v40, s16, 0
  v_msad_u8 v67, v44, s16, 0
  v_msad_u8 v64, v33, s17, v64
  v_msad_u8 v65, v37, s17, v65
  v_msad_u8 v66, v41, s17, v66
  v_msad_u8 v67, v45, s17, v67
  v_msad_u8 v64, v34, s18, v64
  v_msad_u8 v65, v38, s18, v65
  v_msad_u8 v66, v42, s18, v66
  v_msad_u8 v67, v46, s18, v67
  v_msad_u8 v64, v35, s19, v64
  v_msad_u8 v65, v39, s19, v65
  v_msad_u8 v66, v43, s19, v66
  v_msad_u8 v67, v47, s19, v67
  v_or_b32 v64, v64, v68
  v_or_b32 v65, v65, v69
  v_or_b32 v66, v66, v70
  v_or_b32 v67, v67, v71
  v_cmp_ne_u32_e64 s[68:69], 0, v64
  v_cmp_ne_u32_e64 s[70:71], 0, v65
  v_cmp_ne_u32_e64 s[72:73], 0, v66
  v_cmp_ne_u32_e64 s[74:75], 0, v67
  s_or_b64 s[8:9], s[68:69], s[70:71]
  s_or_b64 s[20:21], s[72:73], s[74:75]
  s_or_b64 s[8:9], s[8:9], s[20:21]
  s_cbranch_scc0 L_h1ok
  s_mov_b32 s8, 0
  s_bcnt1_i32_b64 s9, s[68:69]
  s_add_u32 s8, s8, s9
  s_bcnt1_i32_b64 s9, s[70:71]
  s_add_u32 s8, s8, s9
  s_bcnt1_i32_b64 s9, s[72:73]
  s_add_u32 s8, s8, s9
  s_bcnt1_i32_b64 s9, s[74:75]
  s_add_u32 s8, s8, s9
  s_cmp_le_u32 s8, 32
  s_cbranch_scc1 L_h1pipe
L_h1quick:
  buffer_load_dwordx4 v[72:75], v7, s[56:59], s15 offen sc1
  s_waitcnt vmcnt(0)
  v_cmp_eq_u32 vcc, s42, v74
  s_bcnt1_i32_b64 s8, vcc
  s_cmp_ge_u32 s8, 56
  s_cbranch_scc1 L_h1pipe
  s_add_u32 s99, s99, 1
  s_cmp_gt_u32 s99, 20000
  s_cbranch_scc1 L_h1ok
  s_sleep 2
  s_branch L_h1quick
L_h1pipe:
  s_mov_b64 exec, s[68:69]
  buffer_load_dwordx4 v[48:51], v6, s[56:59], s15 offen offset:0 sc1
  buffer_load_dwordx4 v[32:35], v5, s[56:59], s64 offen sc1
  s_mov_b64 exec, s[70:71]
  buffer_load_dwordx4 v[52:55], v6, s[56:59], s15 offen offset:128 sc1
  buffer_load_dwordx4 v[36:39], v5, s[56:59], s65 offen sc1
  s_mov_b64 exec, s[72:73]
  buffer_load_dwordx4 v[56:59], v6, s[56:59], s15 offen offset:256 sc1
  buffer_load_dwordx4 v[40:43], v5, s[56:59], s66 offen sc1
  s_mov_b64 exec, s[74:75]
  buffer_load_dwordx4 v[60:63], v6, s[56:59], s15 offen offset:384 sc1
  buffer_load_dwordx4 v[44:47], v5, s[56:59], s67 offen sc1
  s_mov_b64 exec, -1
  s_waitcnt vmcnt(16)
  v_xor_b32 v68, s42, v50
  v_xor_b32 v69, s42, v54
  v_xor_b32 v70, s42, v58
  v_xor_b32 v71, s42, v62
  v_msad_u8 v64, v32, s16, 0
  v_msad_u8 v65, v36, s16, 0
  v_msad_u8 v66, v40, s16, 0
  v_msad_u8 v67, v44, s16, 0
  v_msad_u8 v64, v33, s17, v64
  v_msad_u8 v65, v37, s17, v65
  v_msad_u8 v66, v41, s17, v66
  v_msad_u8 v67, v45, s17, v67
  v_msad_u8 v64, v34, s18, v64
  v_msad_u8 v65, v38, s18, v65
  v_msad_u8 v66, v42, s18, v66
  v_msad_u8 v67, v46, s18, v67
  v_msad_u8 v64, v35, s19, v64
  v_msad_u8 v65, v39, s19, v65
  v_msad_u8 v66, v43, s19, v66
  v_msad_u8 v67, v47, s19, v67
  v_or_b32 v64, v64, v68
  v_or_b32 v65, v65, v69
  v_or_b32 v66, v66, v70
  v_or_b32 v67, v67, v71
  v_cmp_ne_u32_e64 s[68:69], 0, v64
  v_cmp_ne_u32_e64 s[70:71], 0, v65
  v_cmp_ne_u32_e64 s[72:73], 0, v66
  v_cmp_ne_u32_e64 s[74:75], 0, v67
  s_or_b64 s[8:9], s[68:69], s[70:71]
  s_or_b64 s[20:21], s[72:73], s[74:75]
  s_or_b64 s[8:9], s[8:9], s[20:21]
  s_cbranch_scc0 L_h1ok
  s_add_u32 s99, s99, 1
  s_cmp_gt_u32 s99, 20000
  s_sleep 2
  s_cbranch_scc0 L_h1pipe
L_h1ok:
  v_max3_f32 v4, v48, v52, v56
  v_max_f32 v4, v4, v60
  s_nop 1
  v_max_f32_dpp v4, v4, v4 row_ror:8 row_mask:0xf bank_mask:0xf
  v_mov_b32 v29, v4
  s_nop 1
  v_permlane16_swap_b32 v29, v4
  v_max_f32 v4, v4, v29
  v_mov_b32 v29, v4
  s_nop 1
  v_permlane32_swap_b32 v29, v4
  v_max_f32 v4, v4, v29
  v_and_b32 v80, 0xffffff00, v32
  v_and_b32 v81, 0xffffff00, v33
  v_and_b32 v82, 0xffffff00, v34
  v_and_b32 v83, 0xffffff00, v35
  v_and_b32 v84, 0xffffff00, v36
  v_and_b32 v85, 0xffffff00, v37
  v_and_b32 v86, 0xffffff00, v38
  v_and_b32 v87, 0xffffff00, v39
  v_and_b32 v88, 0xffffff00, v40
  v_and_b32 v89, 0xffffff00, v41
  v_and_b32 v90, 0xffffff00, v42
  v_and_b32 v91, 0xffffff00, v43
  v_and_b32 v92, 0xffffff00, v44
  v_and_b32 v93, 0xffffff00, v45
  v_and_b32 v94, 0xffffff00, v46
  v_and_b32 v95, 0xffffff00, v47
  v_sub_f32 v76, v48, v4
  v_sub_f32 v77, v52, v4
  v_sub_f32 v78, v56, v4
  v_sub_f32 v79, v60, v4
  v_mul_f32 v76, s43, v76
  v_mul_f32 v77, s43, v77
  v_mul_f32 v78, s43, v78
  v_mul_f32 v79, s43, v79
  v_exp_f32 v76, v76
  v_exp_f32 v77, v77
  v_exp_f32 v78, v78
  v_exp_f32 v79, v79
  v_mul_f32 v68, v76, v49
  v_mul_f32 v64, v76, v80
  v_mul_f32 v65, v76, v81
  v_mul_f32 v66, v76, v82
  v_mul_f32 v67, v76, v83
  v_fmac_f32 v68, v77, v53
  v_fmac_f32 v64, v77, v84
  v_fmac_f32 v65, v77, v85
  v_fmac_f32 v66, v77, v86
  v_fmac_f32 v67, v77, v87
  v_fmac_f32 v68, v78, v57
  v_fmac_f32 v64, v78, v88
  v_fmac_f32 v65, v78, v89
  v_fmac_f32 v66, v78, v90
  v_fmac_f32 v67, v78, v91
  v_fmac_f32 v68, v79, v61
  v_fmac_f32 v64, v79, v92
  v_fmac_f32 v65, v79, v93
  v_fmac_f32 v66, v79, v94
  v_fmac_f32 v67, v79, v95
  v_add_f32_dpp v64, v64, v64 row_ror:8 row_mask:0xf bank_mask:0xf
  v_add_f32_dpp v65, v65, v65 row_ror:8 row_mask:0xf bank_mask:0xf
  v_add_f32_dpp v66, v66, v66 row_ror:8 row_mask:0xf bank_mask:0xf
  v_add_f32_dpp v67, v67, v67 row_ror:8 row_mask:0xf bank_mask:0xf
  v_add_f32_dpp v68, v68, v68 row_ror:8 row_mask:0xf bank_mask:0xf
  v_mov_b32 v69, v64
  v_mov_b32 v70, v65
  v_mov_b32 v71, v66
  v_mov_b32 v72, v67
  v_mov_b32 v73, v68
  v_permlane16_swap_b32 v69, v64
  v_permlane16_swap_b32 v70, v65
  v_permlane16_swap_b32 v71, v66
  v_permlane16_swap_b32 v72, v67
  v_permlane16_swap_b32 v73, v68
  v_add_f32 v64, v64, v69
  v_add_f32 v65, v65, v70
  v_add_f32 v66, v66, v71
  v_add_f32 v67, v67, v72
  v_add_f32 v68, v68, v73
  v_mov_b32 v69, v64
  v_mov_b32 v70, v65
  v_mov_b32 v71, v66
  v_mov_b32 v72, v67
  v_mov_b32 v73, v68
  v_permlane32_swap_b32 v69, v64
  v_permlane32_swap_b32 v70, v65
  v_permlane32_swap_b32 v71, v66
  v_permlane32_swap_b32 v72, v67
  v_permlane32_swap_b32 v73, v68
  v_add_f32 v64, v64, v69
  v_add_f32 v65, v65, v70
  v_add_f32 v66, v66, v71
  v_add_f32 v67, v67, v72
  v_add_f32 v68, v68, v73
  v_rcp_f32 v4, v68
  s_nop 0
  v_mul_f32 v74, v64, v4
  v_mul_f32 v75, v65, v4
  v_mul_f32 v76, v66, v4
  v_mul_f32 v77, v67, v4
  v_fma_f32 v64, -v74, v68, v64
  v_fma_f32 v65, -v75, v68, v65
  v_fma_f32 v66, -v76, v68, v66
  v_fma_f32 v67, -v77, v68, v67
  v_fma_f32 v64, v64, v4, v74
  v_fma_f32 v65, v65, v4, v75
  v_fma_f32 v66, v66, v4, v76
  v_fma_f32 v67, v67, v4, v77
  v_cvt_pk_bf16_f32 v78, v64, v65
  v_cvt_pk_bf16_f32 v79, v66, v67
  v_readlane_b32 s64, v78, 0
  v_readlane_b32 s65, v79, 0
  v_readlane_b32 s66, v78, 1
  v_readlane_b32 s67, v79, 1
  v_readlane_b32 s68, v78, 2
  v_readlane_b32 s69, v79, 2
  v_readlane_b32 s70, v78, 3
  v_readlane_b32 s71, v79, 3
  v_readlane_b32 s72, v78, 4
  v_readlane_b32 s73, v79, 4
  v_readlane_b32 s74, v78, 5
  v_readlane_b32 s75, v79, 5
  v_readlane_b32 s76, v78, 6
  v_readlane_b32 s77, v79, 6
  v_readlane_b32 s78, v78, 7
  v_readlane_b32 s79, v79, 7
  v_dot2c_f32_bf16 v8, s64, v96
  v_dot2c_f32_bf16 v9, s64, v97
  v_dot2c_f32_bf16 v10, s64, v98
  v_dot2c_f32_bf16 v11, s64, v99
  v_dot2c_f32_bf16 v8, s65, v100
  v_dot2c_f32_bf16 v9, s65, v101
  v_dot2c_f32_bf16 v10, s65, v102
  v_dot2c_f32_bf16 v11, s65, v103
  v_dot2c_f32_bf16 v8, s66, v104
  v_dot2c_f32_bf16 v9, s66, v105
  v_dot2c_f32_bf16 v10, s66, v106
  v_dot2c_f32_bf16 v11, s66, v107
  v_dot2c_f32_bf16 v8, s67, v108
  v_dot2c_f32_bf16 v9, s67, v109
  v_dot2c_f32_bf16 v10, s67, v110
  v_dot2c_f32_bf16 v11, s67, v111
  v_dot2c_f32_bf16 v8, s68, v112
  v_dot2c_f32_bf16 v9, s68, v113
  v_dot2c_f32_bf16 v10, s68, v114
  v_dot2c_f32_bf16 v11, s68, v115
  v_dot2c_f32_bf16 v8, s69, v116
  v_dot2c_f32_bf16 v9, s69, v117
  v_dot2c_f32_bf16 v10, s69, v118
  v_dot2c_f32_bf16 v11, s69, v119
  v_dot2c_f32_bf16 v8, s70, v120
  v_dot2c_f32_bf16 v9, s70, v121
  v_dot2c_f32_bf16 v10, s70, v122
  v_dot2c_f32_bf16 v11, s70, v123
  v_dot2c_f32_bf16 v8, s71, v124
  v_dot2c_f32_bf16 v9, s71, v125
  v_dot2c_f32_bf16 v10, s71, v126
  v_dot2c_f32_bf16 v11, s71, v127
  v_dot2c_f32_bf16 v8, s72, v128
  v_dot2c_f32_bf16 v9, s72, v129
  v_dot2c_f32_bf16 v10, s72, v130
  v_dot2c_f32_bf16 v11, s72, v131
  v_dot2c_f32_bf16 v8, s73, v132
  v_dot2c_f32_bf16 v9, s73, v133
  v_dot2c_f32_bf16 v10, s73, v134
  v_dot2c_f32_bf16 v11, s73, v135
  v_dot2c_f32_bf16 v8, s74, v136
  v_dot2c_f32_bf16 v9, s74, v137
  v_dot2c_f32_bf16 v10, s74, v138
  v_dot2c_f32_bf16 v11, s74, v139
  v_dot2c_f32_bf16 v8, s75, v140
  v_dot2c_f32_bf16 v9, s75, v141
  v_dot2c_f32_bf16 v10, s75, v142
  v_dot2c_f32_bf16 v11, s75, v143
  v_dot2c_f32_bf16 v8, s76, v144
  v_dot2c_f32_bf16 v9, s76, v145
  v_dot2c_f32_bf16 v10, s76, v146
  v_dot2c_f32_bf16 v11, s76, v147
  v_dot2c_f32_bf16 v8, s77, v148
  v_dot2c_f32_bf16 v9, s77, v149
  v_dot2c_f32_bf16 v10, s77, v150
  v_dot2c_f32_bf16 v11, s77, v151
  v_dot2c_f32_bf16 v8, s78, v152
  v_dot2c_f32_bf16 v9, s78, v153
  v_dot2c_f32_bf16 v10, s78, v154
  v_dot2c_f32_bf16 v11, s78, v155
  v_dot2c_f32_bf16 v8, s79, v156
  v_dot2c_f32_bf16 v9, s79, v157
  v_dot2c_f32_bf16 v10, s79, v158
  v_dot2c_f32_bf16 v11, s79, v159
  v_and_b32 v8, 0xffffff00, v8
  v_and_b32 v9, 0xffffff00, v9
  v_and_b32 v10, 0xffffff00, v10
  v_and_b32 v11, 0xffffff00, v11
  v_or_b32 v8, s16, v8
  v_or_b32 v9, s17, v9
  v_or_b32 v10, s18, v10
  v_or_b32 v11, s19, v11
  buffer_store_dwordx4 v[8:11], v1, s[56:59], s12 offen sc1
  s_cmp_lg_u32 s11, 0
  s_cbranch_scc1 L_fin
  s_mov_b64 s[68:69], -1
  s_mov_b64 s[70:71], -1
  v_mov_b32 v80, 0
  v_mov_b32 v81, 0
  v_mov_b32 v82, 0
  v_mov_b32 v83, 0
  v_mov_b32 v84, 0
  v_mov_b32 v85, 0
  v_mov_b32 v86, 0
  v_mov_b32 v87, 0
  s_sleep 22
  s_mov_b64 exec, s[68:69]
  buffer_load_dwordx4 v[80:83], v2, s[56:59], s13 offen sc1
  s_mov_b64 exec, s[70:71]
  buffer_load_dwordx4 v[84:87], v2, s[56:59], s10 offen sc1
  s_mov_b64 exec, -1
  s_waitcnt vmcnt(0)
  v_mov_b32 v4, 0
  v_mov_b32 v29, 0
  v_msad_u8 v4, v80, s16, v4
  v_msad_u8 v29, v84, s16, v29
  v_msad_u8 v4, v81, s17, v4
  v_msad_u8 v29, v85, s17, v29
  v_msad_u8 v4, v82, s18, v4
  v_msad_u8 v29, v86, s18, v29
  v_msad_u8 v4, v83, s19, v4
  v_msad_u8 v29, v87, s19, v29
  v_cmp_ne_u32_e64 s[68:69], 0, v4
  v_cmp_ne_u32_e64 s[70:71], 0, v29
  s_or_b64 s[8:9], s[68:69], s[70:71]
  s_cbranch_scc0 L_h2ok
L_h2pipe:
  s_mov_b64 exec, s[68:69]
  buffer_load_dwordx4 v[80:83], v2, s[56:59], s13 offen sc1
  s_mov_b64 exec, s[70:71]
  buffer_load_dwordx4 v[84:87], v2, s[56:59], s10 offen sc1
  s_mov_b64 exec, -1
  s_waitcnt vmcnt(4)
  v_mov_b32 v4, 0
  v_mov_b32 v29, 0
  v_msad_u8 v4, v80, s16, v4
  v_msad_u8 v29, v84, s16, v29
  v_msad_u8 v4, v81, s17, v4
  v_msad_u8 v29, v85, s17, v29
  v_msad_u8 v4, v82, s18, v4
  v_msad_u8 v29, v86, s18, v29
  v_msad_u8 v4, v83, s19, v4
  v_msad_u8 v29, v87, s19, v29
  v_cmp_ne_u32_e64 s[68:69], 0, v4
  v_cmp_ne_u32_e64 s[70:71], 0, v29
  s_or_b64 s[8:9], s[68:69], s[70:71]
  s_cbranch_scc0 L_h2ok
  s_add_u32 s99, s99, 1
  s_cmp_gt_u32 s99, 20000
  s_sleep 2
  s_cbranch_scc0 L_h2pipe
L_h2ok:
  v_and_b32 v68, 0xffffff00, v80
  v_and_b32 v69, 0xffffff00, v81
  v_and_b32 v70, 0xffffff00, v82
  v_and_b32 v71, 0xffffff00, v83
  v_and_b32 v72, 0xffffff00, v84
  v_and_b32 v73, 0xffffff00, v85
  v_and_b32 v74, 0xffffff00, v86
  v_and_b32 v75, 0xffffff00, v87
  v_add_f32 v32, v68, v72
  v_add_f32 v33, v69, v73
  v_add_f32 v34, v70, v74
  v_add_f32 v35, v71, v75
  v_add_f32_dpp v32, v32, v32 row_ror:1 row_mask:0xf bank_mask:0xf
  v_add_f32_dpp v33, v33, v33 row_ror:1 row_mask:0xf bank_mask:0xf
  v_add_f32_dpp v34, v34, v34 row_ror:1 row_mask:0xf bank_mask:0xf
  v_add_f32_dpp v35, v35, v35 row_ror:1 row_mask:0xf bank_mask:0xf
  v_add_f32_dpp v32, v32, v32 row_ror:2 row_mask:0xf bank_mask:0xf
  v_add_f32_dpp v33, v33, v33 row_ror:2 row_mask:0xf bank_mask:0xf
  v_add_f32_dpp v34, v34, v34 row_ror:2 row_mask:0xf bank_mask:0xf
  v_add_f32_dpp v35, v35, v35 row_ror:2 row_mask:0xf bank_mask:0xf
  v_add_f32_dpp v32, v32, v32 row_ror:4 row_mask:0xf bank_mask:0xf
  v_add_f32_dpp v33, v33, v33 row_ror:4 row_mask:0xf bank_mask:0xf
  v_add_f32_dpp v34, v34, v34 row_ror:4 row_mask:0xf bank_mask:0xf
  v_add_f32_dpp v35, v35, v35 row_ror:4 row_mask:0xf bank_mask:0xf
  v_add_f32_dpp v32, v32, v32 row_ror:8 row_mask:0xf bank_mask:0xf
  v_add_f32_dpp v33, v33, v33 row_ror:8 row_mask:0xf bank_mask:0xf
  v_add_f32_dpp v34, v34, v34 row_ror:8 row_mask:0xf bank_mask:0xf
  v_add_f32_dpp v35, v35, v35 row_ror:8 row_mask:0xf bank_mask:0xf
  v_mov_b32 v64, v32
  v_mov_b32 v65, v33
  v_mov_b32 v66, v34
  v_mov_b32 v67, v35
  v_permlane16_swap_b32 v64, v32
  v_permlane16_swap_b32 v65, v33
  v_permlane16_swap_b32 v66, v34
  v_permlane16_swap_b32 v67, v35
  v_add_f32 v32, v32, v64
  v_add_f32 v33, v33, v65
  v_add_f32 v34, v34, v66
  v_add_f32 v35, v35, v67
  v_mov_b32 v64, v32
  v_mov_b32 v65, v33
  v_mov_b32 v66, v34
  v_mov_b32 v67, v35
  v_permlane32_swap_b32 v64, v32
  v_permlane32_swap_b32 v65, v33
  v_permlane32_swap_b32 v66, v34
  v_permlane32_swap_b32 v67, v35
  v_add_f32 v32, v32, v64
  v_add_f32 v33, v33, v65
  v_add_f32 v34, v34, v66
  v_add_f32 v35, v35, v67
  v_add_f32 v32, v32, v12
  v_add_f32 v33, v33, v13
  v_add_f32 v34, v34, v14
  v_add_f32 v35, v35, v15
  v_cvt_pk_bf16_f32 v4, v32, v33
  v_cvt_pk_bf16_f32 v5, v34, v35
  v_mov_b32 v6, s14
  s_mov_b64 exec, 1
  buffer_store_dwordx2 v[4:5], v6, s[80:83], 0 offen
  s_cmp_lg_u32 s2, 0
  s_cbranch_scc1 L_fin
  v_mov_b32 v6, s42
  v_mov_b32 v7, 0
  buffer_store_dword v6, v7, s[56:59], 0 offen sc1
L_fin:
  s_waitcnt vmcnt(0)
L_end:
  s_endpgm
.section .rodata,"a"
.p2align 6
.amdhsa_kernel parallel_sum__gqa_block_cached__moe_arch_mod__decode_kernel
  .amdhsa_next_free_vgpr 168
  .amdhsa_next_free_sgpr 102
  .amdhsa_accum_offset 168
  .amdhsa_group_segment_fixed_size 0
  .amdhsa_kernarg_size 104
  .amdhsa_user_sgpr_count 2
  .amdhsa_user_sgpr_kernarg_segment_ptr 1
  .amdhsa_system_sgpr_workgroup_id_x 1
.end_amdhsa_kernel
```
